```python
import torch

def _softmax(x, axis=-1):
    return torch.softmax(x, dim=axis)

def _gelu(x):
    return torch.nn.functional.gelu(x, approximate='tanh')

def _silu(x):
    return torch.nn.functional.silu(x)

def _sigmoid(x):
    return torch.sigmoid(x)

def _layernorm(x, axis=-1, eps=1e-05):
    m = x.mean(dim=axis, keepdim=True)
    v = x.var(dim=axis, keepdim=True, unbiased=False)
    return (x - m) / torch.sqrt(v + eps)

def _scatter_add(tgt, idx, src, axis=0):
    return tgt.clone().index_add_(axis, idx, src)

def _segment_sum(src, seg, n):
    out = torch.zeros((n,) + src.shape[1:], dtype=src.dtype)
    return out.index_add_(0, seg, src)

def _pad(x, pw):
    flat = tuple((v for pair in reversed(pw) for v in pair))
    return torch.nn.functional.pad(x, flat)
kernel_name = 'standalone__swin_window_attn__vision'

def setup_inputs():

    _w = lambda a: (lambda t: t.to(torch.bfloat16) if t.is_floating_point() else t)(torch.as_tensor(a))
    H = W = 384 // 7 * 7
    C, win = (96, 7)
    return {'x': _w((lambda *s: torch.randn(*s, dtype=torch.bfloat16) * 0.4)(1, H, W, C)), 'wqkv': _w((lambda *s: torch.randn(*s, dtype=torch.bfloat16) * 0.4)(C, 3 * C)), 'wo': _w((lambda *s: torch.randn(*s, dtype=torch.bfloat16) * 0.05)(C, C))}

def reference(x, wqkv, wo):
    B, H, W, C = x.shape
    win = 7
    nh, nw = (H // win, W // win)
    xw = (lambda x, *d: x.permute(*d))(x.reshape(B, nh, win, nw, win, C), 0, 1, 3, 2, 4, 5)
    xw = xw.reshape(B * nh * nw, win * win, C)
    qkv = xw @ wqkv
    q, k, v = (qkv[..., :C].clone(), qkv[..., C:2 * C].clone(), qkv[..., 2 * C:].clone())
    scale = C ** (-0.5)
    p = _softmax(torch.einsum('bqc,bkc->bqk', q, k) * scale, axis=-1)
    o = torch.einsum('bqk,bkc->bqc', p, v) @ wo
    o = (lambda x, *d: x.permute(*d))(o.reshape(B, nh, nw, win, win, C), 0, 1, 3, 2, 4, 5)
    return o.reshape(B, H, W, C)
```

```asm
; @launch grid=(243,1,1) block=(768,1,1) lds=163136
.amdgcn_target "amdgcn-amd-amdhsa--gfx950"
.text
.globl standalone__swin_window_attn__vision_kernel
.p2align 8
.type standalone__swin_window_attn__vision_kernel,@function
standalone__swin_window_attn__vision_kernel:
    s_cmpk_ge_u32 s2, 243
    s_cbranch_scc1 L_end
    s_load_dwordx2 s[8:9], s[0:1], 0
    s_load_dwordx2 s[12:13], s[0:1], 8
    v_lshrrev_b32 v20, 6, v0
    s_getpc_b64 s[4:5]
    v_min_u32 v21, 108, v0
    v_lshlrev_b32 v21, 7, v21
    v_readfirstlane_b32 s20, v20
    v_and_b32 v0, 63, v0
    s_mul_i32 s23, s2, 12
    s_cmp_ge_u32 s20, 2
    s_cbranch_scc1 L_nopf
    global_load_dword v28, v21, s[4:5] offset:512
L_nopf:
    s_add_u32 s23, s23, s20
    s_mul_i32 s24, s23, 1214
    s_lshr_b32 s24, s24, 16
    s_mul_i32 s21, s24, 435456
    s_mulk_i32 s23, 1344
    s_add_u32 s21, s21, s23
    s_add_u32 s22, s20, 5
    s_mulk_i32 s22, 9216
    s_addk_i32 s22, 64
    s_mov_b32 s10, 27433728
    s_mov_b32 s11, 0x20000
    s_cmp_ge_u32 s20, 4
    s_cbranch_scc1 L_BC
    s_mov_b32 s41, 71232
    v_mov_b32 v24, v0
    s_mov_b32 m0, s22
    s_add_u32 s24, s21, 3072
    s_mov_b32 s23, 0
L_Xk:
    v_mul_u32_u24 v20, 171, v24
    v_lshrrev_b32 v21, 13, v20
    v_sub_u32 v21, 0, v21
    v_lshrrev_b32 v20, 11, v20
    v_and_b32 v20, 2, v20
    v_xor_b32 v20, v20, v21
    v_and_b32 v20, 3, v20
    v_xor_b32 v20, v20, v24
    v_lshlrev_b32 v20, 4, v20
    v_mul_u32_u24 v21, 781, v24
    v_lshrrev_b32 v25, 16, v21
    v_mad_u32_u24 v25, v25, s41, v20
    v_add_u32 v21, 149952, v21
    v_lshrrev_b32 v26, 16, v21
    v_mad_u32_u24 v26, v26, s41, v20
    v_add_u32 v21, 149952, v21
    v_lshrrev_b32 v27, 16, v21
    v_mad_u32_u24 v27, v27, s41, v20
    s_waitcnt lgkmcnt(0)
    buffer_load_dwordx4 v25, s[8:11], s21 offen nt lds
    buffer_load_dwordx4 v26, s[8:11], s21 offen offset:3072 nt lds
    s_addk_i32 m0, 3072
    v_add_u32 v24, 64, v24
    buffer_load_dwordx4 v27, s[8:11], s24 offen offset:3072 nt lds
    s_addk_i32 m0, -2048
    s_add_u32 s23, s23, 1
    s_cmp_lt_u32 s23, 3
    s_cbranch_scc1 L_Xk
    s_barrier
    s_branch L_consts
L_BC:
    s_cmp_ge_u32 s20, 8
    s_cbranch_scc1 L_consts
    s_setprio 3
    v_lshrrev_b32 v20, 4, v0
    v_sub_u32 v21, 0, v20
    v_xor_b32 v21, v21, v0
    v_and_b32 v21, 3, v21
    v_lshlrev_b32 v21, 4, v21
    v_bfe_u32 v22, v0, 2, 2
    v_lshl_add_u32 v20, v20, 3, v22
    v_mul_u32_u24 v20, 576, v20
    v_add_u32 v23, v20, v21
    s_and_b32 s24, s20, 1
    s_mul_i32 s24, s24, 12
    s_bfe_u32 s25, s20, 0x10001
    s_add_u32 s24, s24, s25
    s_mulk_i32 s24, 192
    s_add_u32 s25, s20, 23
    s_mulk_i32 s25, 3072
    s_mov_b32 s14, 55296
    s_mov_b32 s15, s11
    s_add_u32 m0, s25, 64
    s_movk_i32 s23, 3
    s_waitcnt lgkmcnt(0)
L_Wk1:
    buffer_load_dwordx4 v23, s[12:15], s24 offen offset:0 lds
    s_addk_i32 m0, 960
    s_sub_u32 s23, s23, 1
    buffer_load_dwordx4 v23, s[12:15], s24 offen offset:64 lds
    s_addk_i32 m0, 960
    s_nop 0
    buffer_load_dwordx4 v23, s[12:15], s24 offen offset:128 lds
    s_addk_i32 m0, 10368
    s_add_u32 s24, s24, 18432
    s_cmp_lg_u32 s23, 0
    s_cbranch_scc1 L_Wk1
L_startup_end:
    s_sub_u32 s25, s20, 4
    s_mul_i32 s25, s25, 3
    v_mul_u32_u24 v20, 171, v0
    v_lshrrev_b32 v20, 11, v20
    v_mul_u32_u24 v21, 12, v20
    v_sub_u32 v21, v0, v21
    v_add_u32 v20, s25, v20
    v_lshrrev_b32 v22, 2, v20
    v_sub_u32 v22, 0, v22
    v_and_b32 v24, 2, v20
    v_xor_b32 v22, v22, v24
    v_and_b32 v22, 3, v22
    v_xor_b32 v21, v21, v22
    v_lshlrev_b32 v21, 4, v21
    s_mul_i32 s23, s2, 12
    v_add_u32 v20, s23, v20
    v_mul_u32_u24 v22, 1214, v20
    v_lshrrev_b32 v22, 16, v22
    v_mul_u32_u24 v22, 435456, v22
    v_mul_u32_u24 v20, 1344, v20
    v_add3_u32 v20, v20, v21, v22
    s_mulk_i32 s25, 192
    s_add_u32 m0, s25, 64
    s_mov_b32 s23, 436608
    s_mov_b32 exec_hi, 15
    buffer_load_dwordx4 v20, s[8:11], s23 offen nt lds
    s_mov_b32 exec_hi, -1
L_consts:
    s_load_dwordx4 s[36:39], s[0:1], 16
    v_lshlrev_b32 v1, 4, v0
    v_mul_u32_u24 v20, 171, v0
    v_lshrrev_b32 v21, 13, v20
    v_sub_u32 v21, 0, v21
    v_lshrrev_b32 v20, 11, v20
    v_and_b32 v20, 2, v20
    v_xor_b32 v20, v20, v21
    v_and_b32 v20, 3, v20
    v_xor_b32 v20, v20, v0
    v_lshlrev_b32 v3, 4, v20
    v_mul_u32_u24 v20, 171, v0
    v_add_u32 v20, 10944, v20
    v_lshrrev_b32 v21, 13, v20
    v_sub_u32 v21, 0, v21
    v_lshrrev_b32 v20, 11, v20
    v_and_b32 v20, 2, v20
    v_xor_b32 v20, v20, v21
    v_and_b32 v20, 3, v20
    v_xor_b32 v20, v20, v0
    v_lshlrev_b32 v4, 4, v20
    v_mul_u32_u24 v20, 171, v0
    v_add_u32 v20, 21888, v20
    v_lshrrev_b32 v21, 13, v20
    v_sub_u32 v21, 0, v21
    v_lshrrev_b32 v20, 11, v20
    v_and_b32 v20, 2, v20
    v_xor_b32 v20, v20, v21
    v_and_b32 v20, 3, v20
    v_xor_b32 v20, v20, v0
    v_lshlrev_b32 v5, 4, v20
    v_add_u32 v18, 435584, v5
    s_lshl_b64 s[30:31], -1, 56
    v_add_u32 v11, 434560, v4
    v_add_u32 v17, 363328, v4
    v_cndmask_b32 v17, v17, v11, s[30:31]
    s_lshl_b64 s[30:31], -1, 36
    v_add_u32 v11, 362304, v3
    v_add_u32 v16, 291072, v3
    v_cndmask_b32 v16, v16, v11, s[30:31]
    s_lshl_b64 s[30:31], -1, 16
    v_add_u32 v11, 290048, v5
    v_add_u32 v8, 218816, v5
    v_cndmask_b32 v8, v8, v11, s[30:31]
    v_add_u32 v7, 217792, v4
    s_lshl_b64 s[30:31], -1, 60
    v_add_u32 v11, 216768, v3
    v_add_u32 v6, 145536, v3
    v_cndmask_b32 v6, v6, v11, s[30:31]
    s_lshl_b64 s[30:31], -1, 40
    v_add_u32 v11, 144512, v5
    v_add_u32 v5, 73280, v5
    v_cndmask_b32 v5, v5, v11, s[30:31]
    s_lshl_b64 s[30:31], -1, 20
    v_add_u32 v11, 72256, v4
    v_add_u32 v4, 1024, v4
    v_cndmask_b32 v4, v4, v11, s[30:31]
    v_and_b32 v20, 15, v0
    v_lshrrev_b32 v21, 2, v20
    v_sub_u32 v21, 0, v21
    v_lshrrev_b32 v22, 4, v0
    v_xor_b32 v21, v21, v22
    v_and_b32 v21, 3, v21
    v_lshlrev_b32 v22, 4, v21
    v_lshl_add_u32 v22, v20, 6, v22
    v_and_b32 v32, 2, v20
    v_xor_b32 v21, v21, v32
    v_lshlrev_b32 v21, 4, v21
    v_mul_u32_u24 v32, 192, v20
    v_add_u32 v32, v32, v21
    v_add_u32 v2, s22, v32
    s_lshl_b32 s24, s20, 6
    s_add_u32 s24, s24, 158528
    v_lshl_add_u32 v9, v20, 2, s24
    s_mov_b32 s32, 0x3e16c740
    s_mov_b64 s[34:35], 0xffff
    s_mov_b64 s[48:49], 0
    s_mov_b32 s52, 0x40000000
    s_mov_b64 s[56:57], 1
    v_add_u32 v10, s22, v1
    s_lshl_b32 s24, s20, 7
    s_add_u32 s24, s24, 156992
    v_mov_b32 v11, 0x30000
    v_lshl_add_u32 v12, v0, 1, s24
    v_cndmask_b32 v12, v11, v12, s[34:35]
    s_mov_b32 s30, 0x10001
    s_mov_b32 s31, 0x10001
    v_lshrrev_b32 v13, 1, v0
    v_add_u32 v13, s24, v13
    v_mov_b32 v11, 2368
    v_cndmask_b32 v13, v11, v13, s[30:31]
    s_lshl_b32 s24, s20, 4
    s_add_u32 s25, s24, 156736
    v_mov_b32 v14, s25
    v_and_b32 v15, 0x300, v1
    v_add_u32 v15, s24, v15
    v_add_u32 v11, 3072, v15
    v_cndmask_b32 v15, v15, v11, s[30:31]
    s_mov_b32 s30, 0x30003
    s_mov_b32 s31, 0x30003
    v_mov_b32 v11, 192
    v_cndmask_b32 v15, v11, v15, s[30:31]
    s_waitcnt lgkmcnt(0)
    s_mov_b32 s16, s38
    s_mov_b32 s17, s39
    s_mov_b32 s18, 27433728
    s_mov_b32 s19, 0x20000
    s_cmp_lt_u32 s20, 4
    s_cbranch_scc1 L_A
    s_and_b32 s28, s20, 1
    s_bfe_u32 s29, s20, 0x10001
    s_mul_i32 s24, s29, 3072
    s_lshl_b32 s25, s28, 3
    s_add_u32 s25, s24, s25
    v_add_u32 v31, s25, v1
    s_and_b32 s27, s20, 3
    s_mul_i32 s25, s27, 6144
    v_add_u32 v33, s25, v1
    v_lshrrev_b32 v34, 2, v0
    v_and_b32 v21, 3, v0
    v_lshl_add_u32 v34, v21, 4, v34
    s_lshl_b32 s25, s27, 10
    v_lshl_add_u32 v34, v34, 4, s25
    v_add_u32 v36, s25, v1
    s_lshl_b32 s25, s27, 6
    v_add_u32 v35, s25, v32
    v_and_b32 v37, 0xf0, v1
    s_lshl_b32 s25, s27, 2
    s_add_u32 s25, s25, 156736
    v_add_u32 v37, s25, v37
    s_mul_i32 s25, s28, 3072
    s_cmp_ge_u32 s20, 8
    s_cbranch_scc1 L_C
    s_add_u32 s25, s25, 83008
    v_add_u32 v29, s25, v22
    s_add_u32 s24, s24, 89152
    v_add_u32 v30, s24, v22
    s_waitcnt vmcnt(1)
    s_barrier
    ds_read_b128 v[40:43], v30 offset:0
    ds_read_b128 v[44:47], v29 offset:0
    ds_read_b128 v[48:51], v30 offset:1024
    ds_read_b128 v[52:55], v29 offset:1024
    ds_read_b128 v[56:59], v30 offset:2048
    ds_read_b128 v[60:63], v29 offset:2048
    ds_read_b128 v[64:67], v29 offset:12288
    ds_read_b128 v[68:71], v29 offset:13312
    ds_read_b128 v[72:75], v29 offset:14336
    ds_read_b128 v[76:79], v30 offset:12288
    ds_read_b128 v[80:83], v30 offset:13312
    s_waitcnt lgkmcnt(9)
    v_mfma_f32_16x16x32_bf16 v[84:87], v[44:47], v[40:43], 0
    ds_read_b128 v[88:91], v30 offset:14336
    s_waitcnt lgkmcnt(8)
    v_mfma_f32_16x16x32_bf16 v[84:87], v[52:55], v[48:51], v[84:87]
    s_waitcnt lgkmcnt(6)
    v_mfma_f32_16x16x32_bf16 v[84:87], v[60:63], v[56:59], v[84:87]
    s_waitcnt lgkmcnt(5)
    v_mfma_f32_16x16x32_bf16 v[92:95], v[64:67], v[40:43], 0
    s_waitcnt lgkmcnt(4)
    v_mfma_f32_16x16x32_bf16 v[92:95], v[68:71], v[48:51], v[92:95]
    ds_read_b128 v[96:99], v29 offset:24576
    s_waitcnt lgkmcnt(4)
    v_mfma_f32_16x16x32_bf16 v[92:95], v[72:75], v[56:59], v[92:95]
    ds_read_b128 v[100:103], v29 offset:25600
    s_waitcnt lgkmcnt(4)
    v_mfma_f32_16x16x32_bf16 v[104:107], v[44:47], v[76:79], 0
    ds_read_b128 v[108:111], v29 offset:26624
    s_waitcnt lgkmcnt(4)
    v_mfma_f32_16x16x32_bf16 v[104:107], v[52:55], v[80:83], v[104:107]
    v_mul_f32 v84, s32, v84
    v_mul_f32 v85, s32, v85
    s_waitcnt lgkmcnt(3)
    v_mfma_f32_16x16x32_bf16 v[104:107], v[60:63], v[88:91], v[104:107]
    v_mul_f32 v86, s32, v86
    v_mul_f32 v87, s32, v87
    v_mfma_f32_16x16x32_bf16 v[112:115], v[64:67], v[76:79], 0
    v_cvt_pk_bf16_f32 v84, v84, v85
    v_cvt_pk_bf16_f32 v85, v86, v87
    v_mfma_f32_16x16x32_bf16 v[112:115], v[68:71], v[80:83], v[112:115]
    ds_read_b128 v[116:119], v30 offset:24576
    v_mfma_f32_16x16x32_bf16 v[112:115], v[72:75], v[88:91], v[112:115]
    ds_read_b128 v[120:123], v30 offset:25600
    s_waitcnt lgkmcnt(4)
    v_mfma_f32_16x16x32_bf16 v[124:127], v[96:99], v[40:43], 0
    ds_read_b128 v[40:43], v30 offset:26624
    s_waitcnt lgkmcnt(4)
    v_mfma_f32_16x16x32_bf16 v[124:127], v[100:103], v[48:51], v[124:127]
    ds_write_b64 v31, v[84:85] offset:9280
    s_waitcnt lgkmcnt(4)
    v_mfma_f32_16x16x32_bf16 v[124:127], v[108:111], v[56:59], v[124:127]
    v_mul_f32 v92, s32, v92
    v_mul_f32 v93, s32, v93
    v_mfma_f32_16x16x32_bf16 v[48:51], v[96:99], v[76:79], 0
    v_mul_f32 v94, s32, v94
    v_mul_f32 v95, s32, v95
    v_mfma_f32_16x16x32_bf16 v[48:51], v[100:103], v[80:83], v[48:51]
    v_cvt_pk_bf16_f32 v92, v92, v93
    v_cvt_pk_bf16_f32 v93, v94, v95
    v_mfma_f32_16x16x32_bf16 v[48:51], v[108:111], v[88:91], v[48:51]
    ds_write_b64 v31, v[92:93] offset:10304
    s_waitcnt lgkmcnt(4)
    v_mfma_f32_16x16x32_bf16 v[56:59], v[44:47], v[116:119], 0
    v_mul_f32 v104, s32, v104
    v_mul_f32 v105, s32, v105
    s_waitcnt lgkmcnt(3)
    v_mfma_f32_16x16x32_bf16 v[56:59], v[52:55], v[120:123], v[56:59]
    v_mul_f32 v106, s32, v106
    v_mul_f32 v107, s32, v107
    s_waitcnt lgkmcnt(2)
    v_mfma_f32_16x16x32_bf16 v[56:59], v[60:63], v[40:43], v[56:59]
    v_cvt_pk_bf16_f32 v104, v104, v105
    v_cvt_pk_bf16_f32 v105, v106, v107
    v_mfma_f32_16x16x32_bf16 v[60:63], v[64:67], v[116:119], 0
    ds_write_b64 v31, v[104:105] offset:15424
    v_mfma_f32_16x16x32_bf16 v[60:63], v[68:71], v[120:123], v[60:63]
    v_mul_f32 v112, s32, v112
    v_mul_f32 v113, s32, v113
    v_mfma_f32_16x16x32_bf16 v[60:63], v[72:75], v[40:43], v[60:63]
    v_mul_f32 v114, s32, v114
    v_mul_f32 v115, s32, v115
    v_mfma_f32_16x16x32_bf16 v[104:107], v[96:99], v[116:119], 0
    v_cvt_pk_bf16_f32 v112, v112, v113
    v_cvt_pk_bf16_f32 v113, v114, v115
    v_mfma_f32_16x16x32_bf16 v[104:107], v[100:103], v[120:123], v[104:107]
    ds_write_b64 v31, v[112:113] offset:16448
    v_mfma_f32_16x16x32_bf16 v[104:107], v[108:111], v[40:43], v[104:107]
    v_mul_f32 v124, s32, v124
    v_mul_f32 v125, s32, v125
    v_mul_f32 v126, s32, v126
    v_mul_f32 v127, s32, v127
    v_cvt_pk_bf16_f32 v124, v124, v125
    v_cvt_pk_bf16_f32 v125, v126, v127
    ds_write_b64 v31, v[124:125] offset:11328
    v_mul_f32 v48, s32, v48
    v_mul_f32 v49, s32, v49
    v_mul_f32 v50, s32, v50
    v_mul_f32 v51, s32, v51
    v_cvt_pk_bf16_f32 v48, v48, v49
    v_cvt_pk_bf16_f32 v49, v50, v51
    ds_write_b64 v31, v[48:49] offset:17472
    v_mul_f32 v56, s32, v56
    v_mul_f32 v57, s32, v57
    v_mul_f32 v58, s32, v58
    v_mul_f32 v59, s32, v59
    v_cvt_pk_bf16_f32 v56, v56, v57
    v_cvt_pk_bf16_f32 v57, v58, v59
    ds_write_b64 v31, v[56:57] offset:21568
    v_mul_f32 v60, s32, v60
    v_mul_f32 v61, s32, v61
    v_mul_f32 v62, s32, v62
    v_mul_f32 v63, s32, v63
    v_cvt_pk_bf16_f32 v60, v60, v61
    v_cvt_pk_bf16_f32 v61, v62, v63
    ds_write_b64 v31, v[60:61] offset:22592
    v_mul_f32 v104, s32, v104
    v_mul_f32 v105, s32, v105
    v_mul_f32 v106, s32, v106
    v_mul_f32 v107, s32, v107
    v_cvt_pk_bf16_f32 v104, v104, v105
    v_cvt_pk_bf16_f32 v105, v106, v107
    ds_write_b64 v31, v[104:105] offset:23616
    s_waitcnt lgkmcnt(0)
    s_waitcnt vmcnt(0)
    s_mov_b64 exec, 1
    v_mov_b32 v11, 1
    ds_add_u32 v1, v11 offset:0
    s_mov_b64 exec, -1
    s_movk_i32 s40, 0x7fff
    s_mov_b64 exec, 1
L_poll2:
    ds_read_b32 v11, v1 offset:0
    s_waitcnt lgkmcnt(0)
    v_readfirstlane_b32 s23, v11
    s_nop 1
    s_cmp_ge_u32 s23, 4
    s_cbranch_scc1 L_poll2_d
    s_sub_u32 s40, s40, 1
    s_cbranch_scc0 L_poll2
L_poll2_d:
    s_mov_b64 exec, -1
    s_cmp_eq_u32 s20, 7
    s_cbranch_scc1 L_B2
    ds_read_b128 v[40:43], v32 offset:64
    ds_read_b128 v[44:47], v32 offset:128
    ds_read_b128 v[48:51], v32 offset:192
    ds_read_b128 v[52:55], v33 offset:9280
    ds_read_b128 v[56:59], v33 offset:10304
    ds_read_b128 v[60:63], v33 offset:11328
    ds_read_b128 v[64:67], v33 offset:12352
    ds_read_b128 v[68:71], v33 offset:13376
    ds_read_b128 v[72:75], v33 offset:14400
    ds_read_b128 v[116:119], v35 offset:64
    ds_read_b64_tr_b16 v[84:85], v34 offset:9280
    ds_read_b64_tr_b16 v[86:87], v34 offset:12352
    ds_read_b64_tr_b16 v[88:89], v34 offset:15424
    ds_read_b64_tr_b16 v[90:91], v34 offset:18496
    ds_read_b64_tr_b16 v[92:93], v34 offset:21568
    ds_read_b64_tr_b16 v[94:95], v34 offset:24640
    ds_read_b64_tr_b16 v[96:97], v34 offset:9288
    ds_read_b64_tr_b16 v[98:99], v34 offset:12360
    ds_read_b64_tr_b16 v[100:101], v34 offset:15432
    ds_read_b64_tr_b16 v[102:103], v34 offset:18504
    ds_read_b64_tr_b16 v[104:105], v34 offset:21576
    ds_read_b64_tr_b16 v[106:107], v34 offset:24648
    s_waitcnt lgkmcnt(15)
    v_mfma_f32_16x16x32_bf16 v[76:79], v[52:55], v[40:43], 0
    v_mfma_f32_16x16x32_bf16 v[76:79], v[56:59], v[44:47], v[76:79]
    v_mfma_f32_16x16x32_bf16 v[76:79], v[60:63], v[48:51], v[76:79]
    v_mfma_f32_16x16x32_bf16 v[80:83], v[64:67], v[40:43], 0
    s_waitcnt lgkmcnt(14)
    v_mfma_f32_16x16x32_bf16 v[80:83], v[68:71], v[44:47], v[80:83]
    s_waitcnt lgkmcnt(13)
    v_mfma_f32_16x16x32_bf16 v[80:83], v[72:75], v[48:51], v[80:83]
    s_waitcnt lgkmcnt(10)
    v_mfma_f32_16x16x32_bf16 v[108:111], v[84:87], v[40:43], 0
    s_waitcnt lgkmcnt(8)
    v_mfma_f32_16x16x32_bf16 v[108:111], v[88:91], v[44:47], v[108:111]
    s_waitcnt lgkmcnt(6)
    v_mfma_f32_16x16x32_bf16 v[108:111], v[92:95], v[48:51], v[108:111]
    s_waitcnt lgkmcnt(4)
    v_mfma_f32_16x16x32_bf16 v[112:115], v[96:99], v[40:43], 0
    s_waitcnt lgkmcnt(2)
    v_mfma_f32_16x16x32_bf16 v[112:115], v[100:103], v[44:47], v[112:115]
    s_waitcnt lgkmcnt(0)
    v_mfma_f32_16x16x32_bf16 v[112:115], v[104:107], v[48:51], v[112:115]
    v_cvt_pk_bf16_f32 v76, v76, v77
    v_cvt_pk_bf16_f32 v77, v78, v79
    v_cvt_pk_bf16_f32 v78, v80, v81
    v_cvt_pk_bf16_f32 v79, v82, v83
    s_nop 1
    v_mfma_f32_16x16x32_bf16 v[52:55], v[116:119], v[76:79], 0
    ds_write_b128 v36, v[76:79] offset:3136
    v_cvt_pk_bf16_f32 v108, v108, v109
    v_cvt_pk_bf16_f32 v109, v110, v111
    v_cvt_pk_bf16_f32 v110, v112, v113
    v_cvt_pk_bf16_f32 v111, v114, v115
    ds_write_b128 v36, v[108:111] offset:6208
    s_mov_b32 s30, 0x22222222
    s_mov_b32 s31, 0x22222222
    v_cndmask_b32 v52, v52, v53, s[30:31]
    s_mov_b32 s30, 0x44444444
    s_mov_b32 s31, 0x44444444
    v_cndmask_b32 v52, v52, v54, s[30:31]
    s_mov_b32 s30, 0x88888888
    s_mov_b32 s31, 0x88888888
    v_cndmask_b32 v52, v52, v55, s[30:31]
    s_mov_b32 exec_lo, 0x00f0000f
    s_mov_b32 exec_hi, 0x00000f00
    ds_write_b32 v37, v52
    s_mov_b64 exec, -1
    s_waitcnt lgkmcnt(0)
    s_mov_b64 exec, 1
    v_mov_b32 v11, 1
    ds_add_u32 v1, v11 offset:12
    s_mov_b64 exec, -1
L_B2:
    s_setprio 0
    s_add_u32 m0, s22, 0
    s_nop 0
    buffer_load_dwordx4 v3, s[8:11], s21 offen nt lds
    s_add_u32 m0, s22, 1024
    s_nop 0
    buffer_load_dwordx4 v4, s[8:11], s21 offen nt lds
    s_add_u32 m0, s22, 2048
    s_nop 0
    buffer_load_dwordx4 v5, s[8:11], s21 offen nt lds
    s_add_u32 m0, s22, 3072
    s_nop 0
    buffer_load_dwordx4 v6, s[8:11], s21 offen nt lds
    s_add_u32 m0, s22, 4096
    s_nop 0
    buffer_load_dwordx4 v7, s[8:11], s21 offen nt lds
    s_add_u32 m0, s22, 5120
    s_nop 0
    buffer_load_dwordx4 v8, s[8:11], s21 offen nt lds
    s_add_u32 m0, s22, 6144
    s_nop 0
    buffer_load_dwordx4 v16, s[8:11], s21 offen nt lds
    s_add_u32 m0, s22, 7168
    s_nop 0
    buffer_load_dwordx4 v17, s[8:11], s21 offen nt lds
    s_add_u32 m0, s22, 8192
    s_nop 0
    buffer_load_dwordx4 v18, s[8:11], s21 offen nt lds
    s_movk_i32 s40, 0x7fff
    s_mov_b64 exec, 1
L_poll3:
    ds_read_b32 v11, v1 offset:12
    s_waitcnt lgkmcnt(0)
    v_readfirstlane_b32 s23, v11
    s_nop 1
    s_cmp_ge_u32 s23, 3
    s_cbranch_scc1 L_poll3_d
    s_sleep 2
    s_sub_u32 s40, s40, 1
    s_cbranch_scc0 L_poll3
L_poll3_d:
    s_mov_b64 exec, -1
    s_movk_i32 s40, 0x7fff
    s_mov_b64 exec, 1
L_poll4:
    ds_read_b32 v11, v1 offset:8
    s_waitcnt lgkmcnt(0)
    v_readfirstlane_b32 s23, v11
    s_nop 1
    s_cmp_ge_u32 s23, 4
    s_cbranch_scc1 L_poll4_d
    s_sleep 2
    s_sub_u32 s40, s40, 1
    s_cbranch_scc0 L_poll4
L_poll4_d:
    s_mov_b64 exec, -1
    s_branch L_pre
L_C:
    s_add_u32 s25, s25, 119872
    v_add_u32 v29, s25, v22
    v_lshrrev_b32 v30, 5, v0
    v_mul_u32_u24 v30, 3072, v30
    v_bfe_u32 v22, v0, 4, 1
    v_lshl_add_u32 v30, v22, 9, v30
    v_lshl_add_u32 v30, v20, 4, v30
    s_lshl_b32 s25, s29, 3
    s_add_u32 s25, s25, 126016
    v_add_u32 v30, s25, v30
    s_mul_i32 s24, s27, 1536
    s_add_u32 s24, s24, 158528
    v_and_b32 v21, 0x300, v1
    v_lshl_add_u32 v24, v20, 2, v21
    v_add_u32 v24, s24, v24
    v_mov_b32 v21, 0
    v_lshlrev_b32 v20, 2, v0
    s_mov_b64 exec, 0xffff
    ds_write_b32 v20, v21 offset:0
    s_mov_b64 exec, -1
    ds_write_b32 v20, v21 offset:2368
    ds_write_b32 v20, v21 offset:2624
    ds_write_b32 v20, v21 offset:2880
    s_lshr_b32 s23, s2, 3
    s_lshl_b32 s23, s23, 2
    s_add_u32 s23, s23, s27
    s_min_u32 s23, s23, 95
    s_mul_i32 s24, s23, 576
    s_add_u32 s4, s12, s24
    s_addc_u32 s5, s13, 0
    s_mul_i32 s24, s23, 192
    s_add_u32 s6, s36, s24
    s_addc_u32 s7, s37, 0
    s_waitcnt lgkmcnt(0)
    s_load_dword s3, s[4:5], 384
    s_load_dword s42, s[4:5], 572
    s_load_dword s43, s[6:7], 0
    s_load_dword s33, s[6:7], 128
    v_lshrrev_b32 v20, 4, v0
    v_sub_u32 v21, 0, v20
    v_xor_b32 v21, v21, v0
    v_and_b32 v21, 3, v21
    v_lshlrev_b32 v21, 4, v21
    v_bfe_u32 v22, v0, 2, 2
    v_lshl_add_u32 v20, v20, 3, v22
    v_mul_u32_u24 v20, 576, v20
    v_add_u32 v23, v20, v21
    s_mul_i32 s24, s28, 2304
    s_addk_i32 s24, 384
    s_movk_i32 s26, 18432
    s_mov_b32 s14, 55296
    s_mov_b32 s15, 0x20000
    s_cmp_lt_u32 s20, 10
    s_cbranch_scc1 L_C1
    s_mul_i32 s24, s28, 3072
    s_movk_i32 s26, 6144
    s_mov_b32 s12, s36
    s_mov_b32 s13, s37
    s_movk_i32 s14, 18432
    v_lshrrev_b32 v20, 2, v0
    v_mul_u32_u24 v20, 192, v20
    v_and_b32 v21, 3, v0
    v_lshl_add_u32 v23, v21, 4, v20
L_C1:
    s_mul_i32 s25, s27, 3072
    s_add_u32 m0, s25, 119872
    s_setprio 3
    s_barrier
    s_movk_i32 s23, 3
    s_waitcnt lgkmcnt(0)
L_Wk5:
    buffer_load_dwordx4 v23, s[12:15], s24 offen offset:0 lds
    s_addk_i32 m0, 960
    s_sub_u32 s23, s23, 1
    buffer_load_dwordx4 v23, s[12:15], s24 offen offset:64 lds
    s_addk_i32 m0, 960
    s_nop 0
    buffer_load_dwordx4 v23, s[12:15], s24 offen offset:128 lds
    s_addk_i32 m0, 10368
    s_add_u32 s24, s24, s26
    s_cmp_lg_u32 s23, 0
    s_cbranch_scc1 L_Wk5
    s_movk_i32 s40, 0x7fff
    s_mov_b64 exec, 1
L_poll6:
    ds_read_b32 v11, v1 offset:0
    s_waitcnt lgkmcnt(0)
    v_readfirstlane_b32 s23, v11
    s_nop 1
    s_cmp_ge_u32 s23, 4
    s_cbranch_scc1 L_poll6_d
    s_sleep 1
    s_sub_u32 s40, s40, 1
    s_cbranch_scc0 L_poll6
L_poll6_d:
    s_mov_b64 exec, -1
    s_waitcnt vmcnt(0)
    s_mov_b64 exec, 1
    v_mov_b32 v11, 1
    ds_add_u32 v1, v11 offset:4
    s_mov_b64 exec, -1
    s_setprio 0
    s_movk_i32 s40, 0x7fff
    s_mov_b64 exec, 1
L_poll7:
    ds_read_b32 v11, v1 offset:4
    s_waitcnt lgkmcnt(0)
    v_readfirstlane_b32 s23, v11
    s_nop 1
    s_cmp_ge_u32 s23, 4
    s_cbranch_scc1 L_poll7_d
    s_sub_u32 s40, s40, 1
    s_cbranch_scc0 L_poll7
L_poll7_d:
    s_mov_b64 exec, -1
    ds_read_b64_tr_b16 v[40:41], v30 offset:0
    ds_read_b64_tr_b16 v[42:43], v30 offset:256
    ds_read_b128 v[44:47], v29 offset:0
    ds_read_b64_tr_b16 v[48:49], v30 offset:12288
    ds_read_b64_tr_b16 v[50:51], v30 offset:12544
    ds_read_b128 v[52:55], v29 offset:1024
    ds_read_b64_tr_b16 v[56:57], v30 offset:24576
    ds_read_b64_tr_b16 v[58:59], v30 offset:24832
    ds_read_b128 v[60:63], v29 offset:2048
    ds_read_b128 v[64:67], v29 offset:12288
    ds_read_b128 v[68:71], v29 offset:13312
    ds_read_b128 v[72:75], v29 offset:14336
    ds_read_b64_tr_b16 v[76:77], v30 offset:1024
    ds_read_b64_tr_b16 v[78:79], v30 offset:1280
    ds_read_b64_tr_b16 v[80:81], v30 offset:13312
    ds_read_b64_tr_b16 v[82:83], v30 offset:13568
    s_waitcnt lgkmcnt(13)
    v_mfma_f32_16x16x32_bf16 v[84:87], v[44:47], v[40:43], 0
    ds_read_b64_tr_b16 v[88:89], v30 offset:25600
    ds_read_b64_tr_b16 v[90:91], v30 offset:25856
    s_waitcnt lgkmcnt(12)
    v_mfma_f32_16x16x32_bf16 v[84:87], v[52:55], v[48:51], v[84:87]
    s_waitcnt lgkmcnt(9)
    v_mfma_f32_16x16x32_bf16 v[84:87], v[60:63], v[56:59], v[84:87]
    s_waitcnt lgkmcnt(8)
    v_mfma_f32_16x16x32_bf16 v[92:95], v[64:67], v[40:43], 0
    s_waitcnt lgkmcnt(7)
    v_mfma_f32_16x16x32_bf16 v[92:95], v[68:71], v[48:51], v[92:95]
    ds_read_b128 v[96:99], v29 offset:24576
    s_waitcnt lgkmcnt(7)
    v_mfma_f32_16x16x32_bf16 v[92:95], v[72:75], v[56:59], v[92:95]
    ds_read_b128 v[100:103], v29 offset:25600
    s_waitcnt lgkmcnt(6)
    v_mfma_f32_16x16x32_bf16 v[104:107], v[44:47], v[76:79], 0
    ds_read_b128 v[108:111], v29 offset:26624
    s_waitcnt lgkmcnt(5)
    v_mfma_f32_16x16x32_bf16 v[104:107], v[52:55], v[80:83], v[104:107]
    v_cvt_pk_bf16_f32 v84, v84, v85
    v_cvt_pk_bf16_f32 v85, v86, v87
    s_waitcnt lgkmcnt(3)
    v_mfma_f32_16x16x32_bf16 v[104:107], v[60:63], v[88:91], v[104:107]
    ds_write_b64 v31, v[84:85] offset:27712
    v_mfma_f32_16x16x32_bf16 v[84:87], v[64:67], v[76:79], 0
    v_cvt_pk_bf16_f32 v92, v92, v93
    v_cvt_pk_bf16_f32 v93, v94, v95
    v_mfma_f32_16x16x32_bf16 v[84:87], v[68:71], v[80:83], v[84:87]
    ds_read_b64_tr_b16 v[112:113], v30 offset:2048
    ds_read_b64_tr_b16 v[114:115], v30 offset:2304
    v_mfma_f32_16x16x32_bf16 v[84:87], v[72:75], v[88:91], v[84:87]
    ds_read_b64_tr_b16 v[116:117], v30 offset:14336
    ds_read_b64_tr_b16 v[118:119], v30 offset:14592
    s_waitcnt lgkmcnt(7)
    v_mfma_f32_16x16x32_bf16 v[120:123], v[96:99], v[40:43], 0
    ds_read_b64_tr_b16 v[40:41], v30 offset:26624
    ds_read_b64_tr_b16 v[42:43], v30 offset:26880
    s_waitcnt lgkmcnt(8)
    v_mfma_f32_16x16x32_bf16 v[120:123], v[100:103], v[48:51], v[120:123]
    ds_write_b64 v31, v[92:93] offset:28736
    s_waitcnt lgkmcnt(8)
    v_mfma_f32_16x16x32_bf16 v[120:123], v[108:111], v[56:59], v[120:123]
    v_cvt_pk_bf16_f32 v104, v104, v105
    v_cvt_pk_bf16_f32 v105, v106, v107
    v_mfma_f32_16x16x32_bf16 v[48:51], v[96:99], v[76:79], 0
    ds_write_b64 v31, v[104:105] offset:33856
    v_mfma_f32_16x16x32_bf16 v[48:51], v[100:103], v[80:83], v[48:51]
    v_cvt_pk_bf16_f32 v84, v84, v85
    v_cvt_pk_bf16_f32 v85, v86, v87
    v_mfma_f32_16x16x32_bf16 v[48:51], v[108:111], v[88:91], v[48:51]
    ds_write_b64 v31, v[84:85] offset:34880
    s_waitcnt lgkmcnt(7)
    v_mfma_f32_16x16x32_bf16 v[56:59], v[44:47], v[112:115], 0
    v_cvt_pk_bf16_f32 v120, v120, v121
    v_cvt_pk_bf16_f32 v121, v122, v123
    s_waitcnt lgkmcnt(5)
    v_mfma_f32_16x16x32_bf16 v[56:59], v[52:55], v[116:119], v[56:59]
    ds_write_b64 v31, v[120:121] offset:29760
    s_waitcnt lgkmcnt(4)
    v_mfma_f32_16x16x32_bf16 v[56:59], v[60:63], v[40:43], v[56:59]
    v_cvt_pk_bf16_f32 v48, v48, v49
    v_cvt_pk_bf16_f32 v49, v50, v51
    v_mfma_f32_16x16x32_bf16 v[104:107], v[64:67], v[112:115], 0
    ds_write_b64 v31, v[48:49] offset:35904
    v_mfma_f32_16x16x32_bf16 v[104:107], v[68:71], v[116:119], v[104:107]
    v_mfma_f32_16x16x32_bf16 v[104:107], v[72:75], v[40:43], v[104:107]
    v_mfma_f32_16x16x32_bf16 v[92:95], v[96:99], v[112:115], 0
    s_nop 0
    v_cvt_pk_bf16_f32 v56, v56, v57
    v_mfma_f32_16x16x32_bf16 v[92:95], v[100:103], v[116:119], v[92:95]
    v_cvt_pk_bf16_f32 v57, v58, v59
    ds_write_b64 v31, v[56:57] offset:40000
    v_mfma_f32_16x16x32_bf16 v[92:95], v[108:111], v[40:43], v[92:95]
    s_nop 0
    v_cvt_pk_bf16_f32 v104, v104, v105
    v_cvt_pk_bf16_f32 v105, v106, v107
    ds_write_b64 v31, v[104:105] offset:41024
    s_nop 3
    v_cvt_pk_bf16_f32 v92, v92, v93
    v_cvt_pk_bf16_f32 v93, v94, v95
    ds_write_b64 v31, v[92:93] offset:42048
    s_waitcnt lgkmcnt(0)
    s_mov_b64 exec, 1
    v_mov_b32 v11, 1
    ds_add_u32 v1, v11 offset:8
    s_mov_b64 exec, -1
    s_movk_i32 s40, 0x7fff
    s_mov_b64 exec, 1
L_poll8:
    ds_read_b32 v11, v1 offset:8
    s_waitcnt lgkmcnt(0)
    v_readfirstlane_b32 s23, v11
    s_nop 1
    s_cmp_ge_u32 s23, 4
    s_cbranch_scc1 L_poll8_d
    s_sub_u32 s40, s40, 1
    s_cbranch_scc0 L_poll8
L_poll8_d:
    s_mov_b64 exec, -1
    s_add_u32 m0, s22, 0
    s_nop 0
    buffer_load_dwordx4 v3, s[8:11], s21 offen nt lds
    s_add_u32 m0, s22, 1024
    s_nop 0
    buffer_load_dwordx4 v4, s[8:11], s21 offen nt lds
    s_add_u32 m0, s22, 2048
    s_nop 0
    buffer_load_dwordx4 v5, s[8:11], s21 offen nt lds
    s_add_u32 m0, s22, 3072
    s_nop 0
    buffer_load_dwordx4 v6, s[8:11], s21 offen nt lds
    s_add_u32 m0, s22, 4096
    s_nop 0
    buffer_load_dwordx4 v7, s[8:11], s21 offen nt lds
    s_add_u32 m0, s22, 5120
    s_nop 0
    buffer_load_dwordx4 v8, s[8:11], s21 offen nt lds
    s_add_u32 m0, s22, 6144
    s_nop 0
    buffer_load_dwordx4 v16, s[8:11], s21 offen nt lds
    s_add_u32 m0, s22, 7168
    s_nop 0
    buffer_load_dwordx4 v17, s[8:11], s21 offen nt lds
    s_add_u32 m0, s22, 8192
    s_nop 0
    buffer_load_dwordx4 v18, s[8:11], s21 offen nt lds
    s_cmp_eq_u32 s20, 11
    s_cbranch_scc1 L_C3
    ds_read_b128 v[40:43], v32 offset:64
    ds_read_b128 v[44:47], v32 offset:128
    ds_read_b128 v[48:51], v32 offset:192
    ds_read_b128 v[52:55], v33 offset:27712
    ds_read_b128 v[56:59], v33 offset:28736
    ds_read_b128 v[60:63], v33 offset:29760
    ds_read_b128 v[64:67], v33 offset:30784
    ds_read_b128 v[68:71], v33 offset:31808
    ds_read_b128 v[72:75], v33 offset:32832
    s_waitcnt lgkmcnt(5)
    v_mfma_f32_16x16x32_bf16 v[76:79], v[40:43], v[52:55], 0
    s_waitcnt lgkmcnt(4)
    v_mfma_f32_16x16x32_bf16 v[76:79], v[44:47], v[56:59], v[76:79]
    s_waitcnt lgkmcnt(3)
    v_mfma_f32_16x16x32_bf16 v[76:79], v[48:51], v[60:63], v[76:79]
    s_waitcnt lgkmcnt(2)
    v_mfma_f32_16x16x32_bf16 v[80:83], v[40:43], v[64:67], 0
    s_waitcnt lgkmcnt(1)
    v_mfma_f32_16x16x32_bf16 v[80:83], v[44:47], v[68:71], v[80:83]
    s_waitcnt lgkmcnt(0)
    v_mfma_f32_16x16x32_bf16 v[80:83], v[48:51], v[72:75], v[80:83]
    s_nop 1
    v_cvt_pk_bf16_f32 v76, v76, 0
    v_cvt_pk_bf16_f32 v77, v77, 0
    v_cvt_pk_bf16_f32 v78, v78, 0
    v_cvt_pk_bf16_f32 v79, v79, 0
    s_nop 1
    v_cvt_pk_bf16_f32 v80, v80, 0
    v_cvt_pk_bf16_f32 v81, v81, 0
    v_cvt_pk_bf16_f32 v82, v82, 0
    v_cvt_pk_bf16_f32 v83, v83, 0
    s_mov_b32 exec_hi, 0xffff
    ds_write2_b32 v24, v76, v77 offset0:0 offset1:16
    ds_write2_b32 v24, v78, v79 offset0:32 offset1:48
    ds_write2_b32 v24, v80, v81 offset0:192 offset1:208
    ds_write2_b32 v24, v82, v83 offset0:224 offset1:240
    s_mov_b32 exec_hi, -1
    s_waitcnt lgkmcnt(0)
    s_mov_b64 exec, 1
    v_mov_b32 v11, 1
    ds_add_u32 v1, v11 offset:16
    s_mov_b64 exec, -1
L_C3:
    s_setprio 0
    s_movk_i32 s40, 0x7fff
    s_mov_b64 exec, 1
L_poll9:
    ds_read_b32 v11, v1 offset:12
    s_waitcnt lgkmcnt(0)
    v_readfirstlane_b32 s23, v11
    s_nop 1
    s_cmp_ge_u32 s23, 3
    s_cbranch_scc1 L_poll9_d
    s_sleep 1
    s_sub_u32 s40, s40, 1
    s_cbranch_scc0 L_poll9
L_poll9_d:
    s_mov_b64 exec, -1
    s_movk_i32 s40, 0x7fff
    s_mov_b64 exec, 1
L_poll10:
    ds_read_b32 v11, v1 offset:16
    s_waitcnt lgkmcnt(0)
    v_readfirstlane_b32 s23, v11
    s_nop 1
    s_cmp_ge_u32 s23, 3
    s_cbranch_scc1 L_poll10_d
    s_sleep 1
    s_sub_u32 s40, s40, 1
    s_cbranch_scc0 L_poll10
L_poll10_d:
    s_mov_b64 exec, -1
L_pre:
    s_waitcnt vmcnt(0)
    s_branch L_main2
L_A:
    s_movk_i32 s40, 0x7fff
    s_mov_b64 exec, 1
L_poll11:
    ds_read_b32 v11, v1 offset:0
    s_waitcnt lgkmcnt(0)
    v_readfirstlane_b32 s23, v11
    s_nop 1
    s_cmp_ge_u32 s23, 4
    s_cbranch_scc1 L_poll11_d
    s_sleep 1
    s_sub_u32 s40, s40, 1
    s_cbranch_scc0 L_poll11
L_poll11_d:
    s_mov_b64 exec, -1
    s_waitcnt vmcnt(0)
L_main:
    s_setprio 2
    ds_read_b128 v[20:23], v1 offset:9280
    ds_read_b128 v[24:27], v2 offset:0
    ds_read_b128 v[28:31], v1 offset:10304
    ds_read_b128 v[32:35], v2 offset:64
    ds_read_b128 v[36:39], v1 offset:11328
    ds_read_b128 v[40:43], v2 offset:128
    ds_read_b128 v[44:47], v2 offset:3072
    s_waitcnt lgkmcnt(5)
    v_mfma_f32_16x16x32_bf16 v[48:51], v[20:23], v[24:27], 0
    ds_read_b128 v[52:55], v2 offset:3136
    ds_read_b128 v[56:59], v2 offset:3200
    s_waitcnt lgkmcnt(5)
    v_mfma_f32_16x16x32_bf16 v[48:51], v[28:31], v[32:35], v[48:51]
    ds_read_b128 v[60:63], v2 offset:6144
    s_waitcnt lgkmcnt(4)
    v_mfma_f32_16x16x32_bf16 v[48:51], v[36:39], v[40:43], v[48:51]
    ds_read_b128 v[64:67], v2 offset:6208
    s_waitcnt lgkmcnt(4)
    v_mfma_f32_16x16x32_bf16 v[68:71], v[20:23], v[44:47], 0
    ds_read_b128 v[72:75], v2 offset:6272
    s_waitcnt lgkmcnt(4)
    v_mfma_f32_16x16x32_bf16 v[68:71], v[28:31], v[52:55], v[68:71]
    ds_read_b128 v[76:79], v1 offset:12352
    s_waitcnt lgkmcnt(4)
    v_mfma_f32_16x16x32_bf16 v[68:71], v[36:39], v[56:59], v[68:71]
    ds_read_b128 v[80:83], v1 offset:13376
    s_waitcnt lgkmcnt(4)
    v_mfma_f32_16x16x32_bf16 v[84:87], v[20:23], v[60:63], 0
    ds_read_b128 v[20:23], v1 offset:14400
    s_waitcnt lgkmcnt(4)
    v_mfma_f32_16x16x32_bf16 v[84:87], v[28:31], v[64:67], v[84:87]
    v_cvt_pk_bf16_f32 v48, v48, v49
    v_cvt_pk_bf16_f32 v49, v50, v51
    s_waitcnt lgkmcnt(3)
    v_mfma_f32_16x16x32_bf16 v[84:87], v[36:39], v[72:75], v[84:87]
    ds_read_b128 v[28:31], v1 offset:15424
    s_waitcnt lgkmcnt(3)
    v_mfma_f32_16x16x32_bf16 v[36:39], v[76:79], v[24:27], 0
    ds_read_b128 v[88:91], v1 offset:16448
    s_waitcnt lgkmcnt(3)
    v_mfma_f32_16x16x32_bf16 v[36:39], v[80:83], v[32:35], v[36:39]
    ds_read_b128 v[92:95], v1 offset:17472
    s_waitcnt lgkmcnt(3)
    v_mfma_f32_16x16x32_bf16 v[36:39], v[20:23], v[40:43], v[36:39]
    v_cvt_pk_bf16_f32 v68, v68, v69
    v_cvt_pk_bf16_f32 v69, v70, v71
    v_mfma_f32_16x16x32_bf16 v[96:99], v[76:79], v[44:47], 0
    v_cvt_pk_bf16_f32 v84, v84, v85
    v_cvt_pk_bf16_f32 v85, v86, v87
    v_mfma_f32_16x16x32_bf16 v[96:99], v[80:83], v[52:55], v[96:99]
    v_mfma_f32_16x16x32_bf16 v[96:99], v[20:23], v[56:59], v[96:99]
    s_nop 0
    v_cvt_pk_bf16_f32 v50, v36, v37
    v_mfma_f32_16x16x32_bf16 v[100:103], v[76:79], v[60:63], 0
    v_cvt_pk_bf16_f32 v51, v38, v39
    v_mfma_f32_16x16x32_bf16 v[100:103], v[80:83], v[64:67], v[100:103]
    v_mfma_f32_16x16x32_bf16 v[100:103], v[20:23], v[72:75], v[100:103]
    ds_read_b128 v[20:23], v1 offset:18496
    s_waitcnt lgkmcnt(3)
    v_mfma_f32_16x16x32_bf16 v[36:39], v[28:31], v[24:27], 0
    ds_read_b128 v[76:79], v1 offset:19520
    s_waitcnt lgkmcnt(3)
    v_mfma_f32_16x16x32_bf16 v[36:39], v[88:91], v[32:35], v[36:39]
    ds_read_b128 v[80:83], v1 offset:20544
    s_waitcnt lgkmcnt(3)
    v_mfma_f32_16x16x32_bf16 v[36:39], v[92:95], v[40:43], v[36:39]
    v_cvt_pk_bf16_f32 v70, v96, v97
    v_cvt_pk_bf16_f32 v71, v98, v99
    v_mfma_f32_16x16x32_bf16 v[96:99], v[28:31], v[44:47], 0
    v_cvt_pk_bf16_f32 v86, v100, v101
    v_cvt_pk_bf16_f32 v87, v102, v103
    v_mfma_f32_16x16x32_bf16 v[96:99], v[88:91], v[52:55], v[96:99]
    v_mfma_f32_16x16x32_bf16 v[96:99], v[92:95], v[56:59], v[96:99]
    s_nop 0
    v_cvt_pk_bf16_f32 v36, v36, v37
    v_mfma_f32_16x16x32_bf16 v[100:103], v[28:31], v[60:63], 0
    v_cvt_pk_bf16_f32 v37, v38, v39
    v_mfma_f32_16x16x32_bf16 v[100:103], v[88:91], v[64:67], v[100:103]
    v_mfma_f32_16x16x32_bf16 v[100:103], v[92:95], v[72:75], v[100:103]
    ds_read_b128 v[28:31], v1 offset:21568
    s_waitcnt lgkmcnt(3)
    v_mfma_f32_16x16x32_bf16 v[88:91], v[20:23], v[24:27], 0
    ds_read_b128 v[92:95], v1 offset:22592
    s_waitcnt lgkmcnt(3)
    v_mfma_f32_16x16x32_bf16 v[88:91], v[76:79], v[32:35], v[88:91]
    ds_read_b128 v[104:107], v1 offset:23616
    s_waitcnt lgkmcnt(3)
    v_mfma_f32_16x16x32_bf16 v[88:91], v[80:83], v[40:43], v[88:91]
    v_cvt_pk_bf16_f32 v96, v96, v97
    v_cvt_pk_bf16_f32 v97, v98, v99
    v_mfma_f32_16x16x32_bf16 v[108:111], v[20:23], v[44:47], 0
    v_cvt_pk_bf16_f32 v100, v100, v101
    v_cvt_pk_bf16_f32 v101, v102, v103
    v_mfma_f32_16x16x32_bf16 v[108:111], v[76:79], v[52:55], v[108:111]
    v_mfma_f32_16x16x32_bf16 v[108:111], v[80:83], v[56:59], v[108:111]
    s_nop 0
    v_cvt_pk_bf16_f32 v38, v88, v89
    v_mfma_f32_16x16x32_bf16 v[112:115], v[20:23], v[60:63], 0
    v_cvt_pk_bf16_f32 v39, v90, v91
    v_mfma_f32_16x16x32_bf16 v[112:115], v[76:79], v[64:67], v[112:115]
    v_mfma_f32_16x16x32_bf16 v[112:115], v[80:83], v[72:75], v[112:115]
    ds_read_b128 v[20:23], v1 offset:24640
    s_waitcnt lgkmcnt(3)
    v_mfma_f32_16x16x32_bf16 v[116:119], v[28:31], v[24:27], 0
    ds_read_b128 v[88:91], v1 offset:25664
    s_waitcnt lgkmcnt(3)
    v_mfma_f32_16x16x32_bf16 v[116:119], v[92:95], v[32:35], v[116:119]
    ds_read_b128 v[76:79], v1 offset:26688
    s_waitcnt lgkmcnt(3)
    v_mfma_f32_16x16x32_bf16 v[116:119], v[104:107], v[40:43], v[116:119]
    v_cvt_pk_bf16_f32 v98, v108, v109
    v_cvt_pk_bf16_f32 v99, v110, v111
    v_mfma_f32_16x16x32_bf16 v[80:83], v[28:31], v[44:47], 0
    v_cvt_pk_bf16_f32 v102, v112, v113
    v_cvt_pk_bf16_f32 v103, v114, v115
    v_mfma_f32_16x16x32_bf16 v[80:83], v[92:95], v[52:55], v[80:83]
    v_mfma_f32_16x16x32_bf16 v[80:83], v[104:107], v[56:59], v[80:83]
    s_nop 0
    v_cvt_pk_bf16_f32 v116, v116, v117
    v_mfma_f32_16x16x32_bf16 v[108:111], v[28:31], v[60:63], 0
    v_cvt_pk_bf16_f32 v117, v118, v119
    v_mfma_f32_16x16x32_bf16 v[108:111], v[92:95], v[64:67], v[108:111]
    v_mfma_f32_16x16x32_bf16 v[108:111], v[104:107], v[72:75], v[108:111]
    s_movk_i32 s40, 0x7fff
    s_mov_b64 exec, 1
L_poll12:
    s_setprio 0
    ds_read_b32 v11, v1 offset:12
    s_waitcnt lgkmcnt(0)
    v_readfirstlane_b32 s23, v11
    s_nop 1
    s_cmp_ge_u32 s23, 3
    s_cbranch_scc1 L_poll12_d
    s_sleep 1
    s_sub_u32 s40, s40, 1
    s_cbranch_scc0 L_poll12
L_poll12_d:
    s_mov_b64 exec, -1
    s_setprio 2
    v_mfma_f32_16x16x32_bf16 v[28:31], v[20:23], v[24:27], 0
    ds_read_b128 v[92:95], v15 offset:3136
    v_mfma_f32_16x16x32_bf16 v[28:31], v[88:91], v[32:35], v[28:31]
    ds_read_b128 v[112:115], v15 offset:4160
    v_mfma_f32_16x16x32_bf16 v[28:31], v[76:79], v[40:43], v[28:31]
    ds_read_b128 v[104:107], v15 offset:5184
    v_mfma_f32_16x16x32_bf16 v[120:123], v[20:23], v[44:47], 0
    v_cvt_pk_bf16_f32 v80, v80, v81
    v_cvt_pk_bf16_f32 v81, v82, v83
    v_mfma_f32_16x16x32_bf16 v[120:123], v[88:91], v[52:55], v[120:123]
    v_cvt_pk_bf16_f32 v108, v108, v109
    v_cvt_pk_bf16_f32 v109, v110, v111
    v_mfma_f32_16x16x32_bf16 v[120:123], v[76:79], v[56:59], v[120:123]
    v_cvt_pk_bf16_f32 v118, v28, v29
    v_cvt_pk_bf16_f32 v119, v30, v31
    v_mfma_f32_16x16x32_bf16 v[28:31], v[20:23], v[60:63], 0
    ds_read_b128 v[20:23], v14
    v_mfma_f32_16x16x32_bf16 v[28:31], v[88:91], v[64:67], v[28:31]
    v_mfma_f32_16x16x32_bf16 v[28:31], v[76:79], v[72:75], v[28:31]
    s_waitcnt lgkmcnt(3)
    v_mfma_f32_16x16x32_bf16 v[88:91], v[92:95], v[24:27], 0
    v_cvt_pk_bf16_f32 v82, v120, v121
    v_cvt_pk_bf16_f32 v83, v122, v123
    s_waitcnt lgkmcnt(2)
    v_mfma_f32_16x16x32_bf16 v[88:91], v[112:115], v[32:35], v[88:91]
    s_waitcnt lgkmcnt(0)
    v_add_f32 v23, v20, v21
    v_mfma_f32_16x16x32_bf16 v[88:91], v[104:107], v[40:43], v[88:91]
    v_cvt_pk_bf16_f32 v110, v28, v29
    v_cvt_pk_bf16_f32 v111, v30, v31
    v_mfma_f32_16x16x32_bf16 v[76:79], v[92:95], v[44:47], 0
    v_add_f32 v23, v23, v22
    v_mfma_f32_16x16x32_bf16 v[76:79], v[112:115], v[52:55], v[76:79]
    v_mfma_f32_16x16x32_bf16 v[76:79], v[104:107], v[56:59], v[76:79]
    v_mfma_f32_16x16x32_bf16 v[28:31], v[92:95], v[60:63], 0
    s_nop 0
    v_exp_f32 v20, v89
    v_mfma_f32_16x16x32_bf16 v[28:31], v[112:115], v[64:67], v[28:31]
    v_mfma_f32_16x16x32_bf16 v[28:31], v[104:107], v[72:75], v[28:31]
    v_mfma_f32_16x16x32_bf16 v[92:95], v[24:27], v[48:51], 0
    v_mfma_f32_16x16x32_bf16 v[92:95], v[32:35], v[36:39], v[92:95]
    s_nop 0
    v_exp_f32 v21, v77
    v_mfma_f32_16x16x32_bf16 v[92:95], v[40:43], v[116:119], v[92:95]
    v_mfma_f32_16x16x32_bf16 v[112:115], v[44:47], v[48:51], 0
    v_mfma_f32_16x16x32_bf16 v[112:115], v[52:55], v[36:39], v[112:115]
    s_nop 0
    v_exp_f32 v22, v29
    v_mfma_f32_16x16x32_bf16 v[112:115], v[56:59], v[116:119], v[112:115]
    v_exp_f32 v23, v23
    v_mfma_f32_16x16x32_bf16 v[104:107], v[60:63], v[48:51], 0
    v_add_f32 v48, v20, v21
    v_cndmask_b32 v23, 0, v23, s[56:57]
    v_mfma_f32_16x16x32_bf16 v[104:107], v[64:67], v[36:39], v[104:107]
    v_add_f32 v48, v48, v22
    v_add_f32 v48, v48, v23
    v_mfma_f32_16x16x32_bf16 v[104:107], v[72:75], v[116:119], v[104:107]
    v_exp_f32 v92, v92
    v_mfma_f32_16x16x32_bf16 v[36:39], v[24:27], v[68:71], 0
    v_add_f32_dpp v48, v48, v48 row_ror:8 row_mask:0xf bank_mask:0xf
    v_exp_f32 v93, v93
    v_mfma_f32_16x16x32_bf16 v[36:39], v[32:35], v[96:99], v[36:39]
    v_add_f32_dpp v48, v48, v48 row_ror:4 row_mask:0xf bank_mask:0xf
    v_exp_f32 v94, v94
    v_mfma_f32_16x16x32_bf16 v[36:39], v[40:43], v[80:83], v[36:39]
    v_add_f32_dpp v48, v48, v48 row_ror:2 row_mask:0xf bank_mask:0xf
    v_exp_f32 v95, v95
    v_mfma_f32_16x16x32_bf16 v[116:119], v[44:47], v[68:71], 0
    v_add_f32_dpp v48, v48, v48 row_ror:1 row_mask:0xf bank_mask:0xf
    v_subrev_u32 v49, 0x1f800000, v48
    v_mfma_f32_16x16x32_bf16 v[116:119], v[52:55], v[96:99], v[116:119]
    v_rcp_f32 v48, v48
    v_mfma_f32_16x16x32_bf16 v[116:119], v[56:59], v[80:83], v[116:119]
    v_cmp_le_u32 s[58:59], s52, v49
    v_mul_f32 v20, v20, v48
    v_mfma_f32_16x16x32_bf16 v[124:127], v[60:63], v[68:71], 0
    v_mul_f32 v21, v21, v48
    v_mul_f32 v22, v22, v48
    v_mfma_f32_16x16x32_bf16 v[124:127], v[64:67], v[96:99], v[124:127]
    v_mul_f32 v23, v23, v48
    s_and_b32 s58, s58, 0xffff
    v_mfma_f32_16x16x32_bf16 v[124:127], v[72:75], v[80:83], v[124:127]
    v_cvt_pk_bf16_f32 v20, v20, v21
    v_cvt_pk_bf16_f32 v22, v22, v23
    v_mfma_f32_16x16x32_bf16 v[68:71], v[24:27], v[84:87], 0
    ds_write_b16 v12, v20
    v_mfma_f32_16x16x32_bf16 v[68:71], v[32:35], v[100:103], v[68:71]
    ds_write_b16_d16_hi v12, v20 offset:32
    v_mfma_f32_16x16x32_bf16 v[68:71], v[40:43], v[108:111], v[68:71]
    ds_write_b16 v12, v22 offset:64
    v_mfma_f32_16x16x32_bf16 v[96:99], v[44:47], v[84:87], 0
    ds_write_b16_d16_hi v12, v22 offset:96
    v_mfma_f32_16x16x32_bf16 v[96:99], v[52:55], v[100:103], v[96:99]
    ds_read2_b64 v[20:23], v13 offset0:0 offset1:4
    v_mfma_f32_16x16x32_bf16 v[96:99], v[56:59], v[108:111], v[96:99]
    ds_read2_b64 v[48:51], v13 offset0:8 offset1:12
    v_mfma_f32_16x16x32_bf16 v[80:83], v[60:63], v[84:87], 0
    v_exp_f32 v112, v112
    v_mfma_f32_16x16x32_bf16 v[80:83], v[64:67], v[100:103], v[80:83]
    v_exp_f32 v113, v113
    v_mfma_f32_16x16x32_bf16 v[80:83], v[72:75], v[108:111], v[80:83]
    v_exp_f32 v114, v114
    s_setprio 0
    v_exp_f32 v115, v115
    v_exp_f32 v104, v104
    v_exp_f32 v105, v105
    v_exp_f32 v106, v106
    v_exp_f32 v107, v107
    v_exp_f32 v88, v88
    v_add_f32 v91, v92, v93
    v_cndmask_b32 v88, 0, v88, s[34:35]
    v_add_f32 v90, v88, v94
    v_add_f32 v91, v91, v95
    v_add_f32 v90, v90, v112
    v_add_f32 v91, v91, v113
    v_add_f32 v90, v90, v114
    v_add_f32 v91, v91, v115
    v_add_f32 v90, v90, v104
    v_add_f32 v91, v91, v105
    v_add_f32 v90, v90, v106
    v_add_f32 v91, v91, v107
    v_add_f32 v90, v90, v91
    v_exp_f32 v36, v36
    v_exp_f32 v37, v37
    v_exp_f32 v38, v38
    v_exp_f32 v39, v39
    v_exp_f32 v116, v116
    v_exp_f32 v117, v117
    v_exp_f32 v118, v118
    v_exp_f32 v119, v119
    v_exp_f32 v124, v124
    v_exp_f32 v125, v125
    v_exp_f32 v126, v126
    v_exp_f32 v127, v127
    v_exp_f32 v76, v76
    v_add_f32 v79, v36, v37
    v_cndmask_b32 v76, 0, v76, s[34:35]
    v_add_f32 v78, v76, v38
    v_add_f32 v79, v79, v39
    v_add_f32 v78, v78, v116
    v_add_f32 v79, v79, v117
    v_add_f32 v78, v78, v118
    v_add_f32 v79, v79, v119
    v_add_f32 v78, v78, v124
    v_add_f32 v79, v79, v125
    v_add_f32 v78, v78, v126
    v_add_f32 v79, v79, v127
    v_add_f32 v78, v78, v79
    s_nop 1
    v_permlane32_swap_b32 v90, v78
    v_add_f32 v90, v90, v78
    v_mov_b32 v78, v90
    s_nop 1
    v_permlane16_swap_b32 v90, v78
    v_add_f32 v90, v90, v78
    v_subrev_u32 v91, 0x1f800000, v90
    v_rcp_f32 v90, v90
    v_cmp_le_u32 vcc, s52, v91
    v_mov_b32 v78, v90
    s_nop 1
    v_permlane32_swap_b32 v90, v78
    s_or_b64 s[48:49], s[48:49], vcc
    v_mul_f32 v92, v92, v90
    v_mul_f32 v93, v93, v90
    v_mul_f32 v94, v94, v90
    v_mul_f32 v95, v95, v90
    v_mul_f32 v112, v112, v90
    v_mul_f32 v113, v113, v90
    v_mul_f32 v114, v114, v90
    v_mul_f32 v115, v115, v90
    v_mul_f32 v104, v104, v90
    v_mul_f32 v105, v105, v90
    v_mul_f32 v106, v106, v90
    v_mul_f32 v107, v107, v90
    v_mul_f32 v88, v88, v90
    v_cvt_pk_bf16_f32 v92, v92, v93
    v_cvt_pk_bf16_f32 v93, v94, v95
    v_cvt_pk_bf16_f32 v94, v112, v113
    v_cvt_pk_bf16_f32 v95, v114, v115
    v_cvt_pk_bf16_f32 v104, v104, v105
    v_cvt_pk_bf16_f32 v105, v106, v107
    v_cvt_pk_bf16_f32 v106, v88, 0
    v_mov_b32 v107, 0
    v_mul_f32 v36, v36, v78
    v_mul_f32 v37, v37, v78
    v_mul_f32 v38, v38, v78
    v_mul_f32 v39, v39, v78
    v_mul_f32 v116, v116, v78
    v_mul_f32 v117, v117, v78
    v_mul_f32 v118, v118, v78
    v_mul_f32 v119, v119, v78
    v_mul_f32 v124, v124, v78
    v_mul_f32 v125, v125, v78
    v_mul_f32 v126, v126, v78
    v_mul_f32 v127, v127, v78
    v_mul_f32 v76, v76, v78
    v_cvt_pk_bf16_f32 v36, v36, v37
    v_cvt_pk_bf16_f32 v37, v38, v39
    v_cvt_pk_bf16_f32 v38, v116, v117
    v_cvt_pk_bf16_f32 v39, v118, v119
    v_cvt_pk_bf16_f32 v124, v124, v125
    v_cvt_pk_bf16_f32 v125, v126, v127
    v_cvt_pk_bf16_f32 v126, v76, 0
    v_mov_b32 v127, 0
    v_exp_f32 v68, v68
    v_exp_f32 v69, v69
    v_exp_f32 v70, v70
    v_exp_f32 v71, v71
    v_exp_f32 v96, v96
    v_exp_f32 v97, v97
    v_exp_f32 v98, v98
    v_exp_f32 v99, v99
    v_exp_f32 v80, v80
    v_exp_f32 v81, v81
    v_exp_f32 v82, v82
    v_exp_f32 v83, v83
    v_exp_f32 v28, v28
    v_add_f32 v31, v68, v69
    v_cndmask_b32 v28, 0, v28, s[34:35]
    v_add_f32 v30, v28, v70
    v_add_f32 v31, v31, v71
    v_add_f32 v30, v30, v96
    v_add_f32 v31, v31, v97
    v_add_f32 v30, v30, v98
    v_add_f32 v31, v31, v99
    v_add_f32 v30, v30, v80
    v_add_f32 v31, v31, v81
    v_add_f32 v30, v30, v82
    v_add_f32 v31, v31, v83
    v_add_f32 v30, v30, v31
    v_mov_b32 v31, v30
    s_nop 1
    v_permlane32_swap_b32 v30, v31
    v_add_f32 v30, v30, v31
    v_mov_b32 v31, v30
    s_nop 1
    v_permlane16_swap_b32 v30, v31
    v_add_f32 v30, v30, v31
    v_subrev_u32 v31, 0x1f800000, v30
    v_rcp_f32 v30, v30
    v_cmp_le_u32 vcc, s52, v31
    s_nop 1
    s_or_b64 s[48:49], s[48:49], vcc
    v_mul_f32 v68, v68, v30
    v_mul_f32 v69, v69, v30
    v_mul_f32 v70, v70, v30
    v_mul_f32 v71, v71, v30
    v_mul_f32 v96, v96, v30
    v_mul_f32 v97, v97, v30
    v_mul_f32 v98, v98, v30
    v_mul_f32 v99, v99, v30
    v_mul_f32 v80, v80, v30
    v_mul_f32 v81, v81, v30
    v_mul_f32 v82, v82, v30
    v_mul_f32 v83, v83, v30
    v_mul_f32 v28, v28, v30
    v_cvt_pk_bf16_f32 v68, v68, v69
    v_cvt_pk_bf16_f32 v69, v70, v71
    v_cvt_pk_bf16_f32 v70, v96, v97
    v_cvt_pk_bf16_f32 v71, v98, v99
    v_cvt_pk_bf16_f32 v80, v80, v81
    v_cvt_pk_bf16_f32 v81, v82, v83
    v_cvt_pk_bf16_f32 v82, v28, 0
    v_mov_b32 v83, 0
L_mark:
    s_movk_i32 s40, 0x7fff
    s_mov_b64 exec, 1
L_poll13:
    ds_read_b32 v11, v1 offset:8
    s_waitcnt lgkmcnt(0)
    v_readfirstlane_b32 s23, v11
    s_nop 1
    s_cmp_ge_u32 s23, 4
    s_cbranch_scc1 L_poll13_d
    s_sleep 1
    s_sub_u32 s40, s40, 1
    s_cbranch_scc0 L_poll13
L_poll13_d:
    s_mov_b64 exec, -1
    ds_read_b128 v[28:31], v1 offset:27712
    ds_read_b128 v[84:87], v1 offset:28736
    ds_read_b128 v[76:79], v1 offset:29760
    ds_read_b128 v[128:131], v1 offset:30784
    s_waitcnt lgkmcnt(3)
    s_setprio 3
    v_mfma_f32_16x16x32_bf16 v[132:135], v[24:27], v[28:31], 0
    ds_read_b128 v[120:123], v1 offset:31808
    s_waitcnt lgkmcnt(3)
    v_mfma_f32_16x16x32_bf16 v[132:135], v[32:35], v[84:87], v[132:135]
    ds_read_b128 v[100:103], v1 offset:32832
    s_waitcnt lgkmcnt(3)
    v_mfma_f32_16x16x32_bf16 v[132:135], v[40:43], v[76:79], v[132:135]
    v_mfma_f32_16x16x32_bf16 v[88:91], v[44:47], v[28:31], 0
    v_mfma_f32_16x16x32_bf16 v[88:91], v[52:55], v[84:87], v[88:91]
    v_mfma_f32_16x16x32_bf16 v[88:91], v[56:59], v[76:79], v[88:91]
    v_mfma_f32_16x16x32_bf16 v[96:99], v[60:63], v[28:31], 0
    v_mfma_f32_16x16x32_bf16 v[96:99], v[64:67], v[84:87], v[96:99]
    v_mfma_f32_16x16x32_bf16 v[96:99], v[72:75], v[76:79], v[96:99]
    ds_read_b128 v[28:31], v1 offset:33856
    s_waitcnt lgkmcnt(3)
    v_mfma_f32_16x16x32_bf16 v[84:87], v[24:27], v[128:131], 0
    ds_read_b128 v[76:79], v1 offset:34880
    s_waitcnt lgkmcnt(3)
    v_mfma_f32_16x16x32_bf16 v[84:87], v[32:35], v[120:123], v[84:87]
    ds_read_b128 v[108:111], v1 offset:35904
    s_waitcnt lgkmcnt(3)
    v_mfma_f32_16x16x32_bf16 v[84:87], v[40:43], v[100:103], v[84:87]
    v_cvt_pk_bf16_f32 v132, v132, v133
    v_cvt_pk_bf16_f32 v133, v134, v135
    v_mfma_f32_16x16x32_bf16 v[112:115], v[44:47], v[128:131], 0
    v_cvt_pk_bf16_f32 v134, v88, v89
    v_cvt_pk_bf16_f32 v135, v90, v91
    v_mfma_f32_16x16x32_bf16 v[112:115], v[52:55], v[120:123], v[112:115]
    v_cvt_pk_bf16_f32 v96, v96, v97
    v_cvt_pk_bf16_f32 v97, v98, v99
    v_mfma_f32_16x16x32_bf16 v[112:115], v[56:59], v[100:103], v[112:115]
    v_cvt_pk_bf16_f32 v84, v84, v85
    v_cvt_pk_bf16_f32 v85, v86, v87
    v_mfma_f32_16x16x32_bf16 v[116:119], v[60:63], v[128:131], 0
    v_mfma_f32_16x16x32_bf16 v[116:119], v[64:67], v[120:123], v[116:119]
    v_mfma_f32_16x16x32_bf16 v[116:119], v[72:75], v[100:103], v[116:119]
    ds_read_b128 v[88:91], v1 offset:36928
    s_waitcnt lgkmcnt(3)
    v_mfma_f32_16x16x32_bf16 v[100:103], v[24:27], v[28:31], 0
    ds_read_b128 v[128:131], v1 offset:37952
    s_waitcnt lgkmcnt(3)
    v_mfma_f32_16x16x32_bf16 v[100:103], v[32:35], v[76:79], v[100:103]
    ds_read_b128 v[120:123], v1 offset:38976
    s_waitcnt lgkmcnt(3)
    v_mfma_f32_16x16x32_bf16 v[100:103], v[40:43], v[108:111], v[100:103]
    v_cvt_pk_bf16_f32 v86, v112, v113
    v_cvt_pk_bf16_f32 v87, v114, v115
    v_mfma_f32_16x16x32_bf16 v[112:115], v[44:47], v[28:31], 0
    v_cvt_pk_bf16_f32 v116, v116, v117
    v_cvt_pk_bf16_f32 v117, v118, v119
    v_mfma_f32_16x16x32_bf16 v[112:115], v[52:55], v[76:79], v[112:115]
    v_mfma_f32_16x16x32_bf16 v[112:115], v[56:59], v[108:111], v[112:115]
    s_nop 0
    v_cvt_pk_bf16_f32 v100, v100, v101
    v_mfma_f32_16x16x32_bf16 v[136:139], v[60:63], v[28:31], 0
    v_cvt_pk_bf16_f32 v101, v102, v103
    v_mfma_f32_16x16x32_bf16 v[136:139], v[64:67], v[76:79], v[136:139]
    v_mfma_f32_16x16x32_bf16 v[136:139], v[72:75], v[108:111], v[136:139]
    ds_read_b128 v[28:31], v1 offset:40000
    s_waitcnt lgkmcnt(3)
    v_mfma_f32_16x16x32_bf16 v[76:79], v[24:27], v[88:91], 0
    ds_read_b128 v[108:111], v1 offset:41024
    s_waitcnt lgkmcnt(3)
    v_mfma_f32_16x16x32_bf16 v[76:79], v[32:35], v[128:131], v[76:79]
    ds_read_b128 v[140:143], v1 offset:42048
    s_waitcnt lgkmcnt(3)
    v_mfma_f32_16x16x32_bf16 v[76:79], v[40:43], v[120:123], v[76:79]
    v_cvt_pk_bf16_f32 v102, v112, v113
    v_cvt_pk_bf16_f32 v103, v114, v115
    v_mfma_f32_16x16x32_bf16 v[112:115], v[44:47], v[88:91], 0
    v_cvt_pk_bf16_f32 v136, v136, v137
    v_cvt_pk_bf16_f32 v137, v138, v139
    v_mfma_f32_16x16x32_bf16 v[112:115], v[52:55], v[128:131], v[112:115]
    v_mfma_f32_16x16x32_bf16 v[112:115], v[56:59], v[120:123], v[112:115]
    s_nop 0
    v_cvt_pk_bf16_f32 v76, v76, v77
    v_mfma_f32_16x16x32_bf16 v[144:147], v[60:63], v[88:91], 0
    v_cvt_pk_bf16_f32 v77, v78, v79
    v_mfma_f32_16x16x32_bf16 v[144:147], v[64:67], v[128:131], v[144:147]
    v_mfma_f32_16x16x32_bf16 v[144:147], v[72:75], v[120:123], v[144:147]
    ds_read_b128 v[148:151], v1 offset:43072
    s_waitcnt lgkmcnt(3)
    v_mfma_f32_16x16x32_bf16 v[88:91], v[24:27], v[28:31], 0
    ds_read_b128 v[128:131], v1 offset:44096
    s_waitcnt lgkmcnt(3)
    v_mfma_f32_16x16x32_bf16 v[88:91], v[32:35], v[108:111], v[88:91]
    ds_read_b128 v[120:123], v1 offset:45120
    s_waitcnt lgkmcnt(3)
    v_mfma_f32_16x16x32_bf16 v[88:91], v[40:43], v[140:143], v[88:91]
    s_movk_i32 s40, 0x7fff
    s_mov_b64 exec, 1
L_poll14:
    s_setprio 3
    ds_read_b32 v11, v1 offset:16
    s_waitcnt lgkmcnt(0)
    v_readfirstlane_b32 s23, v11
    s_nop 1
    s_cmp_ge_u32 s23, 3
    s_cbranch_scc1 L_poll14_d
    s_sleep 1
    s_sub_u32 s40, s40, 1
    s_cbranch_scc0 L_poll14
L_poll14_d:
    s_mov_b64 exec, -1
    s_setprio 3
    v_mfma_f32_16x16x32_bf16 v[152:155], v[44:47], v[28:31], 0
    v_cvt_pk_bf16_f32 v78, v112, v113
    v_cvt_pk_bf16_f32 v79, v114, v115
    v_mfma_f32_16x16x32_bf16 v[152:155], v[52:55], v[108:111], v[152:155]
    v_cvt_pk_bf16_f32 v144, v144, v145
    v_cvt_pk_bf16_f32 v145, v146, v147
    v_mfma_f32_16x16x32_bf16 v[152:155], v[56:59], v[140:143], v[152:155]
    v_cvt_pk_bf16_f32 v88, v88, v89
    v_cvt_pk_bf16_f32 v89, v90, v91
    v_mfma_f32_16x16x32_bf16 v[112:115], v[60:63], v[28:31], 0
    v_mfma_f32_16x16x32_bf16 v[112:115], v[64:67], v[108:111], v[112:115]
    v_mfma_f32_16x16x32_bf16 v[112:115], v[72:75], v[140:143], v[112:115]
    v_mfma_f32_16x16x32_bf16 v[28:31], v[24:27], v[148:151], 0
    ds_read2st64_b32 v[98:99], v9 offset0:0 offset1:0
    v_mfma_f32_16x16x32_bf16 v[28:31], v[32:35], v[128:131], v[28:31]
    v_cvt_pk_bf16_f32 v90, v152, v153
    v_cvt_pk_bf16_f32 v91, v154, v155
    v_mfma_f32_16x16x32_bf16 v[28:31], v[40:43], v[120:123], v[28:31]
    ds_read2st64_b32 v[118:119], v9 offset0:3 offset1:3
    v_mfma_f32_16x16x32_bf16 v[108:111], v[44:47], v[148:151], 0
    v_cvt_pk_bf16_f32 v112, v112, v113
    v_cvt_pk_bf16_f32 v113, v114, v115
    v_mfma_f32_16x16x32_bf16 v[108:111], v[52:55], v[128:131], v[108:111]
    ds_read2st64_b32 v[138:139], v9 offset0:6 offset1:6
    v_mfma_f32_16x16x32_bf16 v[108:111], v[56:59], v[120:123], v[108:111]
    s_nop 0
    v_cvt_pk_bf16_f32 v28, v28, v29
    v_mfma_f32_16x16x32_bf16 v[140:143], v[60:63], v[148:151], 0
    ds_read2st64_b32 v[146:147], v9 offset0:9 offset1:9
    v_mfma_f32_16x16x32_bf16 v[140:143], v[64:67], v[128:131], v[140:143]
    v_cvt_pk_bf16_f32 v29, v30, v31
    v_mfma_f32_16x16x32_bf16 v[140:143], v[72:75], v[120:123], v[140:143]
    ds_read2st64_b32 v[114:115], v9 offset0:12 offset1:12
    v_mfma_f32_16x16x32_bf16 v[148:151], v[132:135], v[92:95], 0
    v_cvt_pk_bf16_f32 v30, v108, v109
    v_cvt_pk_bf16_f32 v31, v110, v111
    s_waitcnt lgkmcnt(4)
    v_mfma_f32_16x16x32_bf16 v[148:151], v[96:99], v[104:107], v[148:151]
    v_mfma_f32_16x16x32_bf16 v[72:75], v[84:87], v[92:95], 0
    s_nop 0
    v_cvt_pk_bf16_f32 v140, v140, v141
    s_waitcnt lgkmcnt(3)
    v_mfma_f32_16x16x32_bf16 v[72:75], v[116:119], v[104:107], v[72:75]
    v_cvt_pk_bf16_f32 v141, v142, v143
    ds_read2st64_b32 v[142:143], v9 offset0:15 offset1:15
    v_mfma_f32_16x16x32_bf16 v[108:111], v[100:103], v[92:95], 0
    v_cvt_pk_bf16_f32 v148, v148, v149
    v_cvt_pk_bf16_f32 v149, v150, v151
    s_waitcnt lgkmcnt(3)
    v_mfma_f32_16x16x32_bf16 v[108:111], v[136:139], v[104:107], v[108:111]
    s_nop 0
    v_cvt_pk_bf16_f32 v150, v72, v73
    v_mfma_f32_16x16x32_bf16 v[24:27], v[76:79], v[92:95], 0
    v_cvt_pk_bf16_f32 v151, v74, v75
    ds_write_b128 v2, v[148:151] offset:0
    s_waitcnt lgkmcnt(3)
    v_mfma_f32_16x16x32_bf16 v[24:27], v[144:147], v[104:107], v[24:27]
    s_nop 0
    v_cvt_pk_bf16_f32 v108, v108, v109
    v_mfma_f32_16x16x32_bf16 v[32:35], v[88:91], v[92:95], 0
    v_cvt_pk_bf16_f32 v109, v110, v111
    s_waitcnt lgkmcnt(2)
    v_mfma_f32_16x16x32_bf16 v[32:35], v[112:115], v[104:107], v[32:35]
    v_mfma_f32_16x16x32_bf16 v[72:75], v[28:31], v[92:95], 0
    s_nop 0
    v_cvt_pk_bf16_f32 v110, v24, v25
    s_waitcnt lgkmcnt(1)
    v_mfma_f32_16x16x32_bf16 v[72:75], v[140:143], v[104:107], v[72:75]
    v_cvt_pk_bf16_f32 v111, v26, v27
    ds_write_b128 v2, v[108:111] offset:64
    v_mfma_f32_16x16x32_bf16 v[148:151], v[132:135], v[36:39], 0
    v_cvt_pk_bf16_f32 v32, v32, v33
    v_cvt_pk_bf16_f32 v33, v34, v35
    v_mfma_f32_16x16x32_bf16 v[148:151], v[96:99], v[124:127], v[148:151]
    v_mfma_f32_16x16x32_bf16 v[92:95], v[84:87], v[36:39], 0
    s_nop 0
    v_cvt_pk_bf16_f32 v34, v72, v73
    v_mfma_f32_16x16x32_bf16 v[92:95], v[116:119], v[124:127], v[92:95]
    v_cvt_pk_bf16_f32 v35, v74, v75
    ds_write_b128 v2, v[32:35] offset:128
    v_mfma_f32_16x16x32_bf16 v[72:75], v[100:103], v[36:39], 0
    ds_read_b128 v[128:131], v10 offset:0
    v_mfma_f32_16x16x32_bf16 v[72:75], v[136:139], v[124:127], v[72:75]
    ds_read_b128 v[120:123], v10 offset:1024
    v_mfma_f32_16x16x32_bf16 v[104:107], v[76:79], v[36:39], 0
    ds_read_b128 v[108:111], v10 offset:2048
    v_mfma_f32_16x16x32_bf16 v[104:107], v[144:147], v[124:127], v[104:107]
    v_cvt_pk_bf16_f32 v148, v148, v149
    v_cvt_pk_bf16_f32 v149, v150, v151
    v_mfma_f32_16x16x32_bf16 v[24:27], v[88:91], v[36:39], 0
    s_waitcnt lgkmcnt(2)
    buffer_store_dwordx4 v[128:131], v3, s[16:19], s21 offen sc1 nt
    v_mfma_f32_16x16x32_bf16 v[24:27], v[112:115], v[124:127], v[24:27]
    s_waitcnt lgkmcnt(1)
    buffer_store_dwordx4 v[120:123], v4, s[16:19], s21 offen sc1 nt
    v_mfma_f32_16x16x32_bf16 v[32:35], v[28:31], v[36:39], 0
    s_waitcnt lgkmcnt(0)
    buffer_store_dwordx4 v[108:111], v5, s[16:19], s21 offen sc1 nt
    v_mfma_f32_16x16x32_bf16 v[32:35], v[140:143], v[124:127], v[32:35]
    v_cvt_pk_bf16_f32 v150, v92, v93
    v_cvt_pk_bf16_f32 v151, v94, v95
    v_mfma_f32_16x16x32_bf16 v[36:39], v[132:135], v[68:71], 0
    ds_write_b128 v2, v[148:151] offset:3072
    v_mfma_f32_16x16x32_bf16 v[36:39], v[96:99], v[80:83], v[36:39]
    v_cvt_pk_bf16_f32 v72, v72, v73
    v_cvt_pk_bf16_f32 v73, v74, v75
    v_mfma_f32_16x16x32_bf16 v[108:111], v[84:87], v[68:71], 0
    v_cvt_pk_bf16_f32 v74, v104, v105
    v_cvt_pk_bf16_f32 v75, v106, v107
    v_mfma_f32_16x16x32_bf16 v[108:111], v[116:119], v[80:83], v[108:111]
    ds_write_b128 v2, v[72:75] offset:3136
    v_mfma_f32_16x16x32_bf16 v[92:95], v[100:103], v[68:71], 0
    v_cvt_pk_bf16_f32 v24, v24, v25
    v_cvt_pk_bf16_f32 v25, v26, v27
    v_mfma_f32_16x16x32_bf16 v[92:95], v[136:139], v[80:83], v[92:95]
    v_cvt_pk_bf16_f32 v26, v32, v33
    v_cvt_pk_bf16_f32 v27, v34, v35
    v_mfma_f32_16x16x32_bf16 v[148:151], v[76:79], v[68:71], 0
    ds_write_b128 v2, v[24:27] offset:3200
    v_mfma_f32_16x16x32_bf16 v[148:151], v[144:147], v[80:83], v[148:151]
    ds_read_b128 v[104:107], v10 offset:3072
    v_mfma_f32_16x16x32_bf16 v[72:75], v[88:91], v[68:71], 0
    ds_read_b128 v[32:35], v10 offset:4096
    v_mfma_f32_16x16x32_bf16 v[72:75], v[112:115], v[80:83], v[72:75]
    ds_read_b128 v[24:27], v10 offset:5120
    v_mfma_f32_16x16x32_bf16 v[40:43], v[28:31], v[68:71], 0
    v_cvt_pk_bf16_f32 v36, v36, v37
    v_cvt_pk_bf16_f32 v37, v38, v39
    v_mfma_f32_16x16x32_bf16 v[40:43], v[140:143], v[80:83], v[40:43]
    s_waitcnt lgkmcnt(2)
    buffer_store_dwordx4 v[104:107], v6, s[16:19], s21 offen sc1 nt
    v_mfma_f32_16x16x32_bf16 v[80:83], v[132:135], v[20:23], 0
    s_waitcnt lgkmcnt(1)
    buffer_store_dwordx4 v[32:35], v7, s[16:19], s21 offen sc1 nt
    v_mfma_f32_16x16x32_bf16 v[80:83], v[96:99], v[48:51], v[80:83]
    s_waitcnt lgkmcnt(0)
    buffer_store_dwordx4 v[24:27], v8, s[16:19], s21 offen sc1 nt
    v_mfma_f32_16x16x32_bf16 v[104:107], v[84:87], v[20:23], 0
    v_cvt_pk_bf16_f32 v38, v108, v109
    v_cvt_pk_bf16_f32 v39, v110, v111
    v_mfma_f32_16x16x32_bf16 v[104:107], v[116:119], v[48:51], v[104:107]
    ds_write_b128 v2, v[36:39] offset:6144
    v_mfma_f32_16x16x32_bf16 v[96:99], v[100:103], v[20:23], 0
    v_cvt_pk_bf16_f32 v92, v92, v93
    v_cvt_pk_bf16_f32 v93, v94, v95
    v_mfma_f32_16x16x32_bf16 v[96:99], v[136:139], v[48:51], v[96:99]
    v_cvt_pk_bf16_f32 v94, v148, v149
    v_cvt_pk_bf16_f32 v95, v150, v151
    v_mfma_f32_16x16x32_bf16 v[84:87], v[76:79], v[20:23], 0
    ds_write_b128 v2, v[92:95] offset:6208
    v_mfma_f32_16x16x32_bf16 v[84:87], v[144:147], v[48:51], v[84:87]
    v_cvt_pk_bf16_f32 v72, v72, v73
    v_cvt_pk_bf16_f32 v73, v74, v75
    v_mfma_f32_16x16x32_bf16 v[76:79], v[88:91], v[20:23], 0
    v_cvt_pk_bf16_f32 v74, v40, v41
    v_cvt_pk_bf16_f32 v75, v42, v43
    v_mfma_f32_16x16x32_bf16 v[76:79], v[112:115], v[48:51], v[76:79]
    ds_write_b128 v2, v[72:75] offset:6272
    v_mfma_f32_16x16x32_bf16 v[72:75], v[28:31], v[20:23], 0
    ds_read_b128 v[20:23], v10 offset:6144
    v_mfma_f32_16x16x32_bf16 v[72:75], v[140:143], v[48:51], v[72:75]
    ds_read_b128 v[108:111], v10 offset:7168
    s_setprio 3
    ds_read_b128 v[116:119], v10 offset:8192
    v_cvt_pk_bf16_f32 v80, v80, v81
    v_cvt_pk_bf16_f32 v81, v82, v83
    v_cvt_pk_bf16_f32 v82, v104, v105
    v_cvt_pk_bf16_f32 v83, v106, v107
    v_cvt_pk_bf16_f32 v96, v96, v97
    v_cvt_pk_bf16_f32 v97, v98, v99
    v_cvt_pk_bf16_f32 v98, v84, v85
    s_waitcnt lgkmcnt(2)
    buffer_store_dwordx4 v[20:23], v16, s[16:19], s21 offen sc1 nt
    s_waitcnt lgkmcnt(1)
    buffer_store_dwordx4 v[108:111], v17, s[16:19], s21 offen sc1 nt
    s_waitcnt lgkmcnt(0)
    buffer_store_dwordx4 v[116:119], v18, s[16:19], s21 offen sc1 nt
    s_add_u32 s24, s21, 436608
    v_cvt_pk_bf16_f32 v99, v86, v87
    v_cvt_pk_bf16_f32 v76, v76, v77
    v_cvt_pk_bf16_f32 v77, v78, v79
    v_cvt_pk_bf16_f32 v78, v72, v73
    v_cvt_pk_bf16_f32 v79, v74, v75
    s_mov_b32 exec_lo, 0x10001
    s_mov_b32 exec_hi, 0x10001
    buffer_store_dwordx4 v[80:83], v0, s[16:19], s24 offen offset:0 sc1 nt
    buffer_store_dwordx4 v[96:99], v0, s[16:19], s24 offen offset:64 sc1 nt
    buffer_store_dwordx4 v[76:79], v0, s[16:19], s24 offen offset:128 sc1 nt
    s_mov_b64 exec, -1
    s_or_b32 s48, s48, s58
    s_branch L_chk
L_main2:
    s_setprio 2
    ds_read_b128 v[20:23], v1 offset:9280
    ds_read_b128 v[24:27], v2 offset:0
    ds_read_b128 v[28:31], v1 offset:10304
    ds_read_b128 v[32:35], v2 offset:64
    ds_read_b128 v[36:39], v1 offset:11328
    ds_read_b128 v[40:43], v2 offset:128
    ds_read_b128 v[44:47], v2 offset:3072
    s_waitcnt lgkmcnt(5)
    s_setprio 2
    v_mfma_f32_16x16x32_bf16 v[48:51], v[20:23], v[24:27], 0
    ds_read_b128 v[52:55], v2 offset:3136
    ds_read_b128 v[56:59], v2 offset:3200
    s_waitcnt lgkmcnt(5)
    v_mfma_f32_16x16x32_bf16 v[48:51], v[28:31], v[32:35], v[48:51]
    ds_read_b128 v[60:63], v2 offset:6144
    s_waitcnt lgkmcnt(4)
    v_mfma_f32_16x16x32_bf16 v[48:51], v[36:39], v[40:43], v[48:51]
    ds_read_b128 v[64:67], v2 offset:6208
    s_waitcnt lgkmcnt(4)
    v_mfma_f32_16x16x32_bf16 v[68:71], v[20:23], v[44:47], 0
    ds_read_b128 v[72:75], v2 offset:6272
    s_waitcnt lgkmcnt(4)
    v_mfma_f32_16x16x32_bf16 v[68:71], v[28:31], v[52:55], v[68:71]
    ds_read_b128 v[76:79], v1 offset:12352
    s_waitcnt lgkmcnt(4)
    v_mfma_f32_16x16x32_bf16 v[68:71], v[36:39], v[56:59], v[68:71]
    ds_read_b128 v[80:83], v1 offset:13376
    s_waitcnt lgkmcnt(4)
    v_mfma_f32_16x16x32_bf16 v[84:87], v[20:23], v[60:63], 0
    ds_read_b128 v[20:23], v1 offset:14400
    s_waitcnt lgkmcnt(4)
    v_mfma_f32_16x16x32_bf16 v[84:87], v[28:31], v[64:67], v[84:87]
    v_cvt_pk_bf16_f32 v48, v48, v49
    v_cvt_pk_bf16_f32 v49, v50, v51
    s_waitcnt lgkmcnt(3)
    v_mfma_f32_16x16x32_bf16 v[84:87], v[36:39], v[72:75], v[84:87]
    ds_read_b128 v[28:31], v1 offset:15424
    s_waitcnt lgkmcnt(3)
    v_mfma_f32_16x16x32_bf16 v[36:39], v[76:79], v[24:27], 0
    ds_read_b128 v[88:91], v1 offset:16448
    s_waitcnt lgkmcnt(3)
    v_mfma_f32_16x16x32_bf16 v[36:39], v[80:83], v[32:35], v[36:39]
    ds_read_b128 v[92:95], v1 offset:17472
    s_waitcnt lgkmcnt(3)
    v_mfma_f32_16x16x32_bf16 v[36:39], v[20:23], v[40:43], v[36:39]
    v_cvt_pk_bf16_f32 v68, v68, v69
    v_cvt_pk_bf16_f32 v69, v70, v71
    v_mfma_f32_16x16x32_bf16 v[96:99], v[76:79], v[44:47], 0
    v_cvt_pk_bf16_f32 v84, v84, v85
    v_cvt_pk_bf16_f32 v85, v86, v87
    v_mfma_f32_16x16x32_bf16 v[96:99], v[80:83], v[52:55], v[96:99]
    v_mfma_f32_16x16x32_bf16 v[96:99], v[20:23], v[56:59], v[96:99]
    s_nop 0
    v_cvt_pk_bf16_f32 v50, v36, v37
    v_mfma_f32_16x16x32_bf16 v[100:103], v[76:79], v[60:63], 0
    v_cvt_pk_bf16_f32 v51, v38, v39
    v_mfma_f32_16x16x32_bf16 v[100:103], v[80:83], v[64:67], v[100:103]
    v_mfma_f32_16x16x32_bf16 v[100:103], v[20:23], v[72:75], v[100:103]
    ds_read_b128 v[20:23], v1 offset:18496
    s_waitcnt lgkmcnt(3)
    v_mfma_f32_16x16x32_bf16 v[36:39], v[28:31], v[24:27], 0
    ds_read_b128 v[76:79], v1 offset:19520
    s_waitcnt lgkmcnt(3)
    v_mfma_f32_16x16x32_bf16 v[36:39], v[88:91], v[32:35], v[36:39]
    ds_read_b128 v[80:83], v1 offset:20544
    s_waitcnt lgkmcnt(3)
    v_mfma_f32_16x16x32_bf16 v[36:39], v[92:95], v[40:43], v[36:39]
    v_cvt_pk_bf16_f32 v70, v96, v97
    v_cvt_pk_bf16_f32 v71, v98, v99
    v_mfma_f32_16x16x32_bf16 v[96:99], v[28:31], v[44:47], 0
    v_cvt_pk_bf16_f32 v86, v100, v101
    v_cvt_pk_bf16_f32 v87, v102, v103
    v_mfma_f32_16x16x32_bf16 v[96:99], v[88:91], v[52:55], v[96:99]
    v_mfma_f32_16x16x32_bf16 v[96:99], v[92:95], v[56:59], v[96:99]
    s_nop 0
    v_cvt_pk_bf16_f32 v36, v36, v37
    v_mfma_f32_16x16x32_bf16 v[100:103], v[28:31], v[60:63], 0
    v_cvt_pk_bf16_f32 v37, v38, v39
    v_mfma_f32_16x16x32_bf16 v[100:103], v[88:91], v[64:67], v[100:103]
    v_mfma_f32_16x16x32_bf16 v[100:103], v[92:95], v[72:75], v[100:103]
    ds_read_b128 v[28:31], v1 offset:21568
    s_waitcnt lgkmcnt(3)
    v_mfma_f32_16x16x32_bf16 v[88:91], v[20:23], v[24:27], 0
    ds_read_b128 v[92:95], v1 offset:22592
    s_waitcnt lgkmcnt(3)
    v_mfma_f32_16x16x32_bf16 v[88:91], v[76:79], v[32:35], v[88:91]
    ds_read_b128 v[104:107], v1 offset:23616
    s_waitcnt lgkmcnt(3)
    v_mfma_f32_16x16x32_bf16 v[88:91], v[80:83], v[40:43], v[88:91]
    v_cvt_pk_bf16_f32 v96, v96, v97
    v_cvt_pk_bf16_f32 v97, v98, v99
    v_mfma_f32_16x16x32_bf16 v[108:111], v[20:23], v[44:47], 0
    v_cvt_pk_bf16_f32 v100, v100, v101
    v_cvt_pk_bf16_f32 v101, v102, v103
    v_mfma_f32_16x16x32_bf16 v[108:111], v[76:79], v[52:55], v[108:111]
    v_mfma_f32_16x16x32_bf16 v[108:111], v[80:83], v[56:59], v[108:111]
    s_nop 0
    v_cvt_pk_bf16_f32 v38, v88, v89
    v_mfma_f32_16x16x32_bf16 v[112:115], v[20:23], v[60:63], 0
    v_cvt_pk_bf16_f32 v39, v90, v91
    v_mfma_f32_16x16x32_bf16 v[112:115], v[76:79], v[64:67], v[112:115]
    v_mfma_f32_16x16x32_bf16 v[112:115], v[80:83], v[72:75], v[112:115]
    ds_read_b128 v[20:23], v1 offset:24640
    s_waitcnt lgkmcnt(3)
    v_mfma_f32_16x16x32_bf16 v[116:119], v[28:31], v[24:27], 0
    ds_read_b128 v[88:91], v1 offset:25664
    s_waitcnt lgkmcnt(3)
    v_mfma_f32_16x16x32_bf16 v[116:119], v[92:95], v[32:35], v[116:119]
    ds_read_b128 v[76:79], v1 offset:26688
    s_waitcnt lgkmcnt(3)
    v_mfma_f32_16x16x32_bf16 v[116:119], v[104:107], v[40:43], v[116:119]
    v_cvt_pk_bf16_f32 v98, v108, v109
    v_cvt_pk_bf16_f32 v99, v110, v111
    v_mfma_f32_16x16x32_bf16 v[80:83], v[28:31], v[44:47], 0
    v_cvt_pk_bf16_f32 v102, v112, v113
    v_cvt_pk_bf16_f32 v103, v114, v115
    v_mfma_f32_16x16x32_bf16 v[80:83], v[92:95], v[52:55], v[80:83]
    v_mfma_f32_16x16x32_bf16 v[80:83], v[104:107], v[56:59], v[80:83]
    s_nop 0
    v_cvt_pk_bf16_f32 v116, v116, v117
    v_mfma_f32_16x16x32_bf16 v[108:111], v[28:31], v[60:63], 0
    v_cvt_pk_bf16_f32 v117, v118, v119
    v_mfma_f32_16x16x32_bf16 v[108:111], v[92:95], v[64:67], v[108:111]
    v_mfma_f32_16x16x32_bf16 v[108:111], v[104:107], v[72:75], v[108:111]
    ds_read_b128 v[28:31], v15 offset:3136
    s_waitcnt lgkmcnt(3)
    v_mfma_f32_16x16x32_bf16 v[92:95], v[20:23], v[24:27], 0
    ds_read_b128 v[112:115], v15 offset:4160
    s_waitcnt lgkmcnt(3)
    v_mfma_f32_16x16x32_bf16 v[92:95], v[88:91], v[32:35], v[92:95]
    ds_read_b128 v[104:107], v15 offset:5184
    s_waitcnt lgkmcnt(3)
    v_mfma_f32_16x16x32_bf16 v[92:95], v[76:79], v[40:43], v[92:95]
    v_cvt_pk_bf16_f32 v80, v80, v81
    v_cvt_pk_bf16_f32 v81, v82, v83
    v_mfma_f32_16x16x32_bf16 v[120:123], v[20:23], v[44:47], 0
    v_cvt_pk_bf16_f32 v108, v108, v109
    v_cvt_pk_bf16_f32 v109, v110, v111
    v_mfma_f32_16x16x32_bf16 v[120:123], v[88:91], v[52:55], v[120:123]
    v_mfma_f32_16x16x32_bf16 v[120:123], v[76:79], v[56:59], v[120:123]
    s_nop 0
    v_cvt_pk_bf16_f32 v118, v92, v93
    v_mfma_f32_16x16x32_bf16 v[124:127], v[20:23], v[60:63], 0
    v_cvt_pk_bf16_f32 v119, v94, v95
    v_mfma_f32_16x16x32_bf16 v[124:127], v[88:91], v[64:67], v[124:127]
    v_mfma_f32_16x16x32_bf16 v[124:127], v[76:79], v[72:75], v[124:127]
    s_waitcnt lgkmcnt(2)
    v_mfma_f32_16x16x32_bf16 v[20:23], v[28:31], v[24:27], 0
    v_cvt_pk_bf16_f32 v82, v120, v121
    v_cvt_pk_bf16_f32 v83, v122, v123
    s_waitcnt lgkmcnt(1)
    v_mfma_f32_16x16x32_bf16 v[20:23], v[112:115], v[32:35], v[20:23]
    s_waitcnt lgkmcnt(0)
    v_mfma_f32_16x16x32_bf16 v[20:23], v[104:107], v[40:43], v[20:23]
    v_cvt_pk_bf16_f32 v110, v124, v125
    v_cvt_pk_bf16_f32 v111, v126, v127
    v_mfma_f32_16x16x32_bf16 v[76:79], v[28:31], v[44:47], 0
    v_mfma_f32_16x16x32_bf16 v[76:79], v[112:115], v[52:55], v[76:79]
    v_mfma_f32_16x16x32_bf16 v[76:79], v[104:107], v[56:59], v[76:79]
    v_mfma_f32_16x16x32_bf16 v[92:95], v[28:31], v[60:63], 0
    v_mfma_f32_16x16x32_bf16 v[92:95], v[112:115], v[64:67], v[92:95]
    v_mfma_f32_16x16x32_bf16 v[92:95], v[104:107], v[72:75], v[92:95]
    v_mfma_f32_16x16x32_bf16 v[88:91], v[24:27], v[48:51], 0
    v_mfma_f32_16x16x32_bf16 v[88:91], v[32:35], v[36:39], v[88:91]
    v_mfma_f32_16x16x32_bf16 v[88:91], v[40:43], v[116:119], v[88:91]
    v_mfma_f32_16x16x32_bf16 v[28:31], v[44:47], v[48:51], 0
    v_mfma_f32_16x16x32_bf16 v[28:31], v[52:55], v[36:39], v[28:31]
    v_mfma_f32_16x16x32_bf16 v[28:31], v[56:59], v[116:119], v[28:31]
    v_mfma_f32_16x16x32_bf16 v[112:115], v[60:63], v[48:51], 0
    v_mfma_f32_16x16x32_bf16 v[112:115], v[64:67], v[36:39], v[112:115]
    v_mfma_f32_16x16x32_bf16 v[112:115], v[72:75], v[116:119], v[112:115]
    ds_read_b128 v[48:51], v1 offset:27712
    v_mfma_f32_16x16x32_bf16 v[36:39], v[24:27], v[68:71], 0
    ds_read_b128 v[104:107], v1 offset:28736
    v_mfma_f32_16x16x32_bf16 v[36:39], v[32:35], v[96:99], v[36:39]
    ds_read_b128 v[116:119], v1 offset:29760
    v_mfma_f32_16x16x32_bf16 v[36:39], v[40:43], v[80:83], v[36:39]
    v_exp_f32 v88, v88
    v_mfma_f32_16x16x32_bf16 v[128:131], v[44:47], v[68:71], 0
    v_exp_f32 v89, v89
    v_mfma_f32_16x16x32_bf16 v[128:131], v[52:55], v[96:99], v[128:131]
    v_exp_f32 v90, v90
    v_mfma_f32_16x16x32_bf16 v[128:131], v[56:59], v[80:83], v[128:131]
    v_exp_f32 v91, v91
    v_mfma_f32_16x16x32_bf16 v[132:135], v[60:63], v[68:71], 0
    v_exp_f32 v28, v28
    v_mfma_f32_16x16x32_bf16 v[132:135], v[64:67], v[96:99], v[132:135]
    v_exp_f32 v29, v29
    v_mfma_f32_16x16x32_bf16 v[132:135], v[72:75], v[80:83], v[132:135]
    ds_read_b128 v[68:71], v1 offset:30784
    s_waitcnt lgkmcnt(3)
    v_mfma_f32_16x16x32_bf16 v[96:99], v[24:27], v[48:51], 0
    ds_read_b128 v[80:83], v1 offset:31808
    s_waitcnt lgkmcnt(3)
    v_mfma_f32_16x16x32_bf16 v[96:99], v[32:35], v[104:107], v[96:99]
    ds_read_b128 v[120:123], v1 offset:32832
    s_waitcnt lgkmcnt(3)
    v_mfma_f32_16x16x32_bf16 v[96:99], v[40:43], v[116:119], v[96:99]
    v_exp_f32 v30, v30
    v_mfma_f32_16x16x32_bf16 v[124:127], v[44:47], v[48:51], 0
    v_exp_f32 v31, v31
    v_mfma_f32_16x16x32_bf16 v[124:127], v[52:55], v[104:107], v[124:127]
    v_exp_f32 v112, v112
    v_mfma_f32_16x16x32_bf16 v[124:127], v[56:59], v[116:119], v[124:127]
    v_exp_f32 v113, v113
    v_mfma_f32_16x16x32_bf16 v[136:139], v[60:63], v[48:51], 0
    v_cvt_pk_bf16_f32 v96, v96, v97
    v_cvt_pk_bf16_f32 v97, v98, v99
    v_mfma_f32_16x16x32_bf16 v[136:139], v[64:67], v[104:107], v[136:139]
    v_exp_f32 v114, v114
    v_mfma_f32_16x16x32_bf16 v[136:139], v[72:75], v[116:119], v[136:139]
    ds_read_b128 v[48:51], v1 offset:33856
    s_waitcnt lgkmcnt(3)
    v_mfma_f32_16x16x32_bf16 v[104:107], v[24:27], v[68:71], 0
    ds_read_b128 v[116:119], v1 offset:34880
    s_waitcnt lgkmcnt(3)
    v_mfma_f32_16x16x32_bf16 v[104:107], v[32:35], v[80:83], v[104:107]
    ds_read_b128 v[140:143], v1 offset:35904
    s_waitcnt lgkmcnt(3)
    v_mfma_f32_16x16x32_bf16 v[104:107], v[40:43], v[120:123], v[104:107]
    v_cvt_pk_bf16_f32 v98, v124, v125
    v_cvt_pk_bf16_f32 v99, v126, v127
    v_mfma_f32_16x16x32_bf16 v[124:127], v[44:47], v[68:71], 0
    v_cvt_pk_bf16_f32 v136, v136, v137
    v_cvt_pk_bf16_f32 v137, v138, v139
    v_mfma_f32_16x16x32_bf16 v[124:127], v[52:55], v[80:83], v[124:127]
    v_exp_f32 v115, v115
    v_mfma_f32_16x16x32_bf16 v[124:127], v[56:59], v[120:123], v[124:127]
    v_cvt_pk_bf16_f32 v104, v104, v105
    v_cvt_pk_bf16_f32 v105, v106, v107
    v_mfma_f32_16x16x32_bf16 v[144:147], v[60:63], v[68:71], 0
    v_exp_f32 v20, v20
    v_mfma_f32_16x16x32_bf16 v[144:147], v[64:67], v[80:83], v[144:147]
    v_add_f32 v23, v88, v89
    v_cndmask_b32 v20, 0, v20, s[34:35]
    v_mfma_f32_16x16x32_bf16 v[144:147], v[72:75], v[120:123], v[144:147]
    ds_read_b128 v[148:151], v1 offset:36928
    s_waitcnt lgkmcnt(3)
    v_mfma_f32_16x16x32_bf16 v[68:71], v[24:27], v[48:51], 0
    ds_read_b128 v[80:83], v1 offset:37952
    s_waitcnt lgkmcnt(3)
    v_mfma_f32_16x16x32_bf16 v[68:71], v[32:35], v[116:119], v[68:71]
    ds_read_b128 v[120:123], v1 offset:38976
    s_waitcnt lgkmcnt(3)
    v_mfma_f32_16x16x32_bf16 v[68:71], v[40:43], v[140:143], v[68:71]
    v_cvt_pk_bf16_f32 v106, v124, v125
    v_cvt_pk_bf16_f32 v107, v126, v127
    v_mfma_f32_16x16x32_bf16 v[124:127], v[44:47], v[48:51], 0
    v_cvt_pk_bf16_f32 v144, v144, v145
    v_cvt_pk_bf16_f32 v145, v146, v147
    v_mfma_f32_16x16x32_bf16 v[124:127], v[52:55], v[116:119], v[124:127]
    v_add_f32 v22, v20, v90
    v_add_f32 v23, v23, v91
    v_mfma_f32_16x16x32_bf16 v[124:127], v[56:59], v[140:143], v[124:127]
    v_cvt_pk_bf16_f32 v68, v68, v69
    v_cvt_pk_bf16_f32 v69, v70, v71
    v_mfma_f32_16x16x32_bf16 v[152:155], v[60:63], v[48:51], 0
    v_add_f32 v22, v22, v28
    v_add_f32 v23, v23, v29
    v_mfma_f32_16x16x32_bf16 v[152:155], v[64:67], v[116:119], v[152:155]
    v_add_f32 v22, v22, v30
    v_add_f32 v23, v23, v31
    v_mfma_f32_16x16x32_bf16 v[152:155], v[72:75], v[140:143], v[152:155]
    ds_read_b128 v[48:51], v1 offset:40000
    s_waitcnt lgkmcnt(3)
    v_mfma_f32_16x16x32_bf16 v[116:119], v[24:27], v[148:151], 0
    v_cvt_pk_bf16_f32 v70, v124, v125
    v_cvt_pk_bf16_f32 v71, v126, v127
    s_waitcnt lgkmcnt(2)
    v_mfma_f32_16x16x32_bf16 v[116:119], v[32:35], v[80:83], v[116:119]
    ds_read_b128 v[140:143], v1 offset:41024
    s_waitcnt lgkmcnt(2)
    v_mfma_f32_16x16x32_bf16 v[116:119], v[40:43], v[120:123], v[116:119]
    v_cvt_pk_bf16_f32 v152, v152, v153
    v_cvt_pk_bf16_f32 v153, v154, v155
    v_mfma_f32_16x16x32_bf16 v[124:127], v[44:47], v[148:151], 0
    v_add_f32 v22, v22, v112
    v_add_f32 v23, v23, v113
    v_mfma_f32_16x16x32_bf16 v[124:127], v[52:55], v[80:83], v[124:127]
    v_add_f32 v22, v22, v114
    v_add_f32 v23, v23, v115
    v_mfma_f32_16x16x32_bf16 v[124:127], v[56:59], v[120:123], v[124:127]
    v_cvt_pk_bf16_f32 v116, v116, v117
    v_cvt_pk_bf16_f32 v117, v118, v119
    v_mfma_f32_16x16x32_bf16 v[156:159], v[60:63], v[148:151], 0
    v_add_f32 v22, v22, v23
    v_exp_f32 v36, v36
    v_mfma_f32_16x16x32_bf16 v[156:159], v[64:67], v[80:83], v[156:159]
    v_exp_f32 v37, v37
    v_mfma_f32_16x16x32_bf16 v[156:159], v[72:75], v[120:123], v[156:159]
    ds_read_b128 v[148:151], v1 offset:42048
    s_waitcnt lgkmcnt(2)
    v_mfma_f32_16x16x32_bf16 v[80:83], v[24:27], v[48:51], 0
    v_cvt_pk_bf16_f32 v118, v124, v125
    v_cvt_pk_bf16_f32 v119, v126, v127
    s_waitcnt lgkmcnt(1)
    v_mfma_f32_16x16x32_bf16 v[80:83], v[32:35], v[140:143], v[80:83]
    v_exp_f32 v38, v38
    s_setprio 0
    v_cvt_pk_bf16_f32 v156, v156, v157
    v_cvt_pk_bf16_f32 v157, v158, v159
    v_exp_f32 v39, v39
    v_exp_f32 v128, v128
    v_exp_f32 v129, v129
    s_waitcnt lgkmcnt(0)
    s_setprio 2
    v_mfma_f32_16x16x32_bf16 v[80:83], v[40:43], v[148:151], v[80:83]
    v_exp_f32 v130, v130
    v_mfma_f32_16x16x32_bf16 v[160:163], v[44:47], v[48:51], 0
    v_exp_f32 v131, v131
    v_mfma_f32_16x16x32_bf16 v[160:163], v[52:55], v[140:143], v[160:163]
    v_exp_f32 v132, v132
    v_mfma_f32_16x16x32_bf16 v[160:163], v[56:59], v[148:151], v[160:163]
    v_exp_f32 v133, v133
    v_mfma_f32_16x16x32_bf16 v[164:167], v[60:63], v[48:51], 0
    v_cvt_pk_bf16_f32 v80, v80, v81
    v_cvt_pk_bf16_f32 v81, v82, v83
    v_mfma_f32_16x16x32_bf16 v[164:167], v[64:67], v[140:143], v[164:167]
    v_exp_f32 v134, v134
    v_mfma_f32_16x16x32_bf16 v[164:167], v[72:75], v[148:151], v[164:167]
    ds_read_b128 v[48:51], v1 offset:43072
    s_setprio 0
    v_cvt_pk_bf16_f32 v82, v160, v161
    v_cvt_pk_bf16_f32 v83, v162, v163
    ds_read_b128 v[160:163], v1 offset:44096
    v_exp_f32 v135, v135
    v_exp_f32 v76, v76
    v_add_f32 v79, v36, v37
    v_cndmask_b32 v76, 0, v76, s[34:35]
    v_cvt_pk_bf16_f32 v164, v164, v165
    v_cvt_pk_bf16_f32 v165, v166, v167
    v_add_f32 v78, v76, v38
    v_add_f32 v79, v79, v39
    s_waitcnt lgkmcnt(1)
    s_setprio 2
    v_mfma_f32_16x16x32_bf16 v[120:123], v[24:27], v[48:51], 0
    v_add_f32 v78, v78, v128
    v_add_f32 v79, v79, v129
    v_add_f32 v78, v78, v130
    s_waitcnt lgkmcnt(0)
    v_mfma_f32_16x16x32_bf16 v[120:123], v[32:35], v[160:163], v[120:123]
    ds_read_b128 v[124:127], v1 offset:45120
    s_setprio 0
    s_cmp_ge_u32 s20, 8
    s_cbranch_scc1 L_cp15
    s_movk_i32 s40, 0x7fff
    s_mov_b64 exec, 1
L_poll16:
    ds_read_b32 v11, v1 offset:16
    s_waitcnt lgkmcnt(0)
    v_readfirstlane_b32 s23, v11
    s_nop 1
    s_cmp_ge_u32 s23, 3
    s_cbranch_scc1 L_poll16_d
    s_sleep 1
    s_sub_u32 s40, s40, 1
    s_cbranch_scc0 L_poll16
L_poll16_d:
    s_mov_b64 exec, -1
L_cp15:
    ds_read2st64_b32 v[138:139], v9 offset0:0 offset1:0
    v_add_f32 v79, v79, v131
    v_add_f32 v78, v78, v132
    v_add_f32 v79, v79, v133
    v_add_f32 v78, v78, v134
    v_add_f32 v79, v79, v135
    v_add_f32 v78, v78, v79
    s_nop 1
    v_permlane32_swap_b32 v22, v78
    s_waitcnt lgkmcnt(1)
    s_setprio 2
    v_mfma_f32_16x16x32_bf16 v[120:123], v[40:43], v[124:127], v[120:123]
    ds_read2st64_b32 v[146:147], v9 offset0:3 offset1:3
    v_mfma_f32_16x16x32_bf16 v[140:143], v[44:47], v[48:51], 0
    v_add_f32 v22, v22, v78
    v_mov_b32 v78, v22
    v_mfma_f32_16x16x32_bf16 v[140:143], v[52:55], v[160:163], v[140:143]
    ds_read2st64_b32 v[154:155], v9 offset0:6 offset1:6
    v_mfma_f32_16x16x32_bf16 v[140:143], v[56:59], v[124:127], v[140:143]
    v_permlane16_swap_b32 v22, v78
    v_mfma_f32_16x16x32_bf16 v[148:151], v[60:63], v[48:51], 0
    ds_read2st64_b32 v[158:159], v9 offset0:9 offset1:9
    v_mfma_f32_16x16x32_bf16 v[148:151], v[64:67], v[160:163], v[148:151]
    v_cvt_pk_bf16_f32 v120, v120, v121
    v_cvt_pk_bf16_f32 v121, v122, v123
    v_mfma_f32_16x16x32_bf16 v[148:151], v[72:75], v[124:127], v[148:151]
    ds_read2st64_b32 v[166:167], v9 offset0:12 offset1:12
    s_setprio 0
    v_cvt_pk_bf16_f32 v122, v140, v141
    v_cvt_pk_bf16_f32 v123, v142, v143
    v_add_f32 v22, v22, v78
    v_subrev_u32 v23, 0x1f800000, v22
    v_rcp_f32 v22, v22
    v_cmp_le_u32 vcc, s52, v23
    v_mov_b32 v78, v22
    v_cvt_pk_bf16_f32 v148, v148, v149
    v_cvt_pk_bf16_f32 v149, v150, v151
    v_permlane32_swap_b32 v22, v78
    s_or_b64 s[48:49], s[48:49], vcc
    v_mul_f32 v88, v88, v22
    v_mul_f32 v89, v89, v22
    v_mul_f32 v90, v90, v22
    v_mul_f32 v91, v91, v22
    v_mul_f32 v28, v28, v22
    v_mul_f32 v29, v29, v22
    v_mul_f32 v30, v30, v22
    v_mul_f32 v31, v31, v22
    v_mul_f32 v112, v112, v22
    v_mul_f32 v113, v113, v22
    v_mul_f32 v114, v114, v22
    v_mul_f32 v115, v115, v22
    v_mul_f32 v20, v20, v22
    v_cvt_pk_bf16_f32 v88, v88, v89
    v_cvt_pk_bf16_f32 v89, v90, v91
    v_cvt_pk_bf16_f32 v90, v28, v29
    v_cvt_pk_bf16_f32 v91, v30, v31
    v_cvt_pk_bf16_f32 v112, v112, v113
    v_cvt_pk_bf16_f32 v113, v114, v115
    s_setprio 2
    v_mfma_f32_16x16x32_bf16 v[48:51], v[96:99], v[88:91], 0
    v_cvt_pk_bf16_f32 v114, v20, 0
    v_mov_b32 v115, 0
    v_mul_f32 v36, v36, v78
    v_mul_f32 v37, v37, v78
    s_waitcnt lgkmcnt(4)
    v_mfma_f32_16x16x32_bf16 v[48:51], v[136:139], v[112:115], v[48:51]
    ds_read2st64_b32 v[150:151], v9 offset0:15 offset1:15
    v_mfma_f32_16x16x32_bf16 v[160:163], v[104:107], v[88:91], 0
    v_mul_f32 v38, v38, v78
    v_mul_f32 v39, v39, v78
    s_waitcnt lgkmcnt(4)
    v_mfma_f32_16x16x32_bf16 v[160:163], v[144:147], v[112:115], v[160:163]
    v_mul_f32 v128, v128, v78
    v_mul_f32 v129, v129, v78
    v_mfma_f32_16x16x32_bf16 v[124:127], v[68:71], v[88:91], 0
    v_cvt_pk_bf16_f32 v48, v48, v49
    v_cvt_pk_bf16_f32 v49, v50, v51
    s_waitcnt lgkmcnt(3)
    v_mfma_f32_16x16x32_bf16 v[124:127], v[152:155], v[112:115], v[124:127]
    v_mul_f32 v130, v130, v78
    v_cvt_pk_bf16_f32 v50, v160, v161
    v_mfma_f32_16x16x32_bf16 v[140:143], v[116:119], v[88:91], 0
    v_cvt_pk_bf16_f32 v51, v162, v163
    ds_write_b128 v2, v[48:51] offset:0
    s_waitcnt lgkmcnt(3)
    v_mfma_f32_16x16x32_bf16 v[140:143], v[156:159], v[112:115], v[140:143]
    v_mul_f32 v131, v131, v78
    v_cvt_pk_bf16_f32 v124, v124, v125
    v_mfma_f32_16x16x32_bf16 v[28:31], v[80:83], v[88:91], 0
    v_cvt_pk_bf16_f32 v125, v126, v127
    v_mul_f32 v132, v132, v78
    s_waitcnt lgkmcnt(2)
    v_mfma_f32_16x16x32_bf16 v[28:31], v[164:167], v[112:115], v[28:31]
    v_mul_f32 v133, v133, v78
    v_cvt_pk_bf16_f32 v126, v140, v141
    v_mfma_f32_16x16x32_bf16 v[160:163], v[120:123], v[88:91], 0
    v_cvt_pk_bf16_f32 v127, v142, v143
    ds_write_b128 v2, v[124:127] offset:64
    s_waitcnt lgkmcnt(2)
    v_mfma_f32_16x16x32_bf16 v[160:163], v[148:151], v[112:115], v[160:163]
    v_mul_f32 v134, v134, v78
    v_cvt_pk_bf16_f32 v28, v28, v29
    v_mfma_f32_16x16x32_bf16 v[48:51], v[24:27], v[84:87], 0
    v_cvt_pk_bf16_f32 v29, v30, v31
    v_mul_f32 v135, v135, v78
    v_mfma_f32_16x16x32_bf16 v[48:51], v[32:35], v[100:103], v[48:51]
    v_mul_f32 v76, v76, v78
    v_cvt_pk_bf16_f32 v36, v36, v37
    v_mfma_f32_16x16x32_bf16 v[48:51], v[40:43], v[108:111], v[48:51]
    v_cvt_pk_bf16_f32 v30, v160, v161
    v_cvt_pk_bf16_f32 v31, v162, v163
    v_mfma_f32_16x16x32_bf16 v[88:91], v[44:47], v[84:87], 0
    ds_write_b128 v2, v[28:31] offset:128
    v_mfma_f32_16x16x32_bf16 v[88:91], v[52:55], v[100:103], v[88:91]
    ds_read_b128 v[140:143], v10 offset:0
    v_mfma_f32_16x16x32_bf16 v[88:91], v[56:59], v[108:111], v[88:91]
    ds_read_b128 v[124:127], v10 offset:1024
    v_mfma_f32_16x16x32_bf16 v[112:115], v[60:63], v[84:87], 0
    ds_read_b128 v[160:163], v10 offset:2048
    v_mfma_f32_16x16x32_bf16 v[112:115], v[64:67], v[100:103], v[112:115]
    v_cvt_pk_bf16_f32 v37, v38, v39
    v_cvt_pk_bf16_f32 v38, v128, v129
    v_mfma_f32_16x16x32_bf16 v[112:115], v[72:75], v[108:111], v[112:115]
    s_waitcnt lgkmcnt(2)
    buffer_store_dwordx4 v[140:143], v3, s[16:19], s21 offen sc1 nt
    s_setprio 0
    s_waitcnt lgkmcnt(1)
    buffer_store_dwordx4 v[124:127], v4, s[16:19], s21 offen sc1 nt
    s_waitcnt lgkmcnt(0)
    buffer_store_dwordx4 v[160:163], v5, s[16:19], s21 offen sc1 nt
    v_cvt_pk_bf16_f32 v39, v130, v131
    v_cvt_pk_bf16_f32 v132, v132, v133
    v_cvt_pk_bf16_f32 v133, v134, v135
    s_setprio 2
    v_mfma_f32_16x16x32_bf16 v[100:103], v[96:99], v[36:39], 0
    v_cvt_pk_bf16_f32 v134, v76, 0
    v_mov_b32 v135, 0
    v_exp_f32 v48, v48
    v_exp_f32 v49, v49
    v_mfma_f32_16x16x32_bf16 v[100:103], v[136:139], v[132:135], v[100:103]
    v_exp_f32 v50, v50
    v_mfma_f32_16x16x32_bf16 v[108:111], v[104:107], v[36:39], 0
    v_exp_f32 v51, v51
    v_mfma_f32_16x16x32_bf16 v[108:111], v[144:147], v[132:135], v[108:111]
    v_exp_f32 v88, v88
    v_mfma_f32_16x16x32_bf16 v[140:143], v[68:71], v[36:39], 0
    v_exp_f32 v89, v89
    v_mfma_f32_16x16x32_bf16 v[140:143], v[152:155], v[132:135], v[140:143]
    v_cvt_pk_bf16_f32 v100, v100, v101
    v_cvt_pk_bf16_f32 v101, v102, v103
    v_mfma_f32_16x16x32_bf16 v[160:163], v[116:119], v[36:39], 0
    v_exp_f32 v90, v90
    v_mfma_f32_16x16x32_bf16 v[160:163], v[156:159], v[132:135], v[160:163]
    v_cvt_pk_bf16_f32 v102, v108, v109
    v_cvt_pk_bf16_f32 v103, v110, v111
    v_mfma_f32_16x16x32_bf16 v[108:111], v[80:83], v[36:39], 0
    ds_write_b128 v2, v[100:103] offset:3072
    v_mfma_f32_16x16x32_bf16 v[108:111], v[164:167], v[132:135], v[108:111]
    v_cvt_pk_bf16_f32 v140, v140, v141
    v_cvt_pk_bf16_f32 v141, v142, v143
    v_mfma_f32_16x16x32_bf16 v[100:103], v[120:123], v[36:39], 0
    v_cvt_pk_bf16_f32 v142, v160, v161
    v_cvt_pk_bf16_f32 v143, v162, v163
    v_mfma_f32_16x16x32_bf16 v[100:103], v[148:151], v[132:135], v[100:103]
    ds_write_b128 v2, v[140:143] offset:3136
    s_setprio 0
    v_exp_f32 v91, v91
    v_cvt_pk_bf16_f32 v108, v108, v109
    v_cvt_pk_bf16_f32 v109, v110, v111
    v_exp_f32 v112, v112
    v_exp_f32 v113, v113
    v_exp_f32 v114, v114
    v_exp_f32 v115, v115
    v_cvt_pk_bf16_f32 v110, v100, v101
    v_cvt_pk_bf16_f32 v111, v102, v103
    ds_write_b128 v2, v[108:111] offset:3200
    ds_read_b128 v[160:163], v10 offset:3072
    ds_read_b128 v[140:143], v10 offset:4096
    ds_read_b128 v[100:103], v10 offset:5120
    v_exp_f32 v92, v92
    v_add_f32 v95, v48, v49
    v_cndmask_b32 v92, 0, v92, s[34:35]
    v_add_f32 v94, v92, v50
    v_add_f32 v95, v95, v51
    v_add_f32 v94, v94, v88
    v_add_f32 v95, v95, v89
    v_add_f32 v94, v94, v90
    s_waitcnt lgkmcnt(2)
    buffer_store_dwordx4 v[160:163], v6, s[16:19], s21 offen sc1 nt
    s_waitcnt lgkmcnt(1)
    buffer_store_dwordx4 v[140:143], v7, s[16:19], s21 offen sc1 nt
    s_waitcnt lgkmcnt(0)
    buffer_store_dwordx4 v[100:103], v8, s[16:19], s21 offen sc1 nt
    v_add_f32 v95, v95, v91
    v_add_f32 v94, v94, v112
    v_add_f32 v95, v95, v113
    v_add_f32 v94, v94, v114
    v_add_f32 v95, v95, v115
    v_add_f32 v94, v94, v95
    v_mov_b32 v95, v94
    s_nop 1
    v_permlane32_swap_b32 v94, v95
    v_add_f32 v94, v94, v95
    v_mov_b32 v95, v94
    s_nop 1
    v_permlane16_swap_b32 v94, v95
    v_add_f32 v94, v94, v95
    v_subrev_u32 v95, 0x1f800000, v94
    v_rcp_f32 v94, v94
    v_cmp_le_u32 vcc, s52, v95
    s_nop 1
    s_or_b64 s[48:49], s[48:49], vcc
    v_mul_f32 v48, v48, v94
    v_mul_f32 v49, v49, v94
    v_mul_f32 v50, v50, v94
    v_mul_f32 v51, v51, v94
    v_mul_f32 v88, v88, v94
    v_mul_f32 v89, v89, v94
    v_mul_f32 v90, v90, v94
    v_mul_f32 v91, v91, v94
    v_mul_f32 v112, v112, v94
    v_mul_f32 v113, v113, v94
    v_mul_f32 v114, v114, v94
    v_mul_f32 v115, v115, v94
    v_mul_f32 v92, v92, v94
    v_cvt_pk_bf16_f32 v48, v48, v49
    v_cvt_pk_bf16_f32 v49, v50, v51
    v_cvt_pk_bf16_f32 v50, v88, v89
    v_cvt_pk_bf16_f32 v51, v90, v91
    v_cvt_pk_bf16_f32 v112, v112, v113
    v_cvt_pk_bf16_f32 v113, v114, v115
    s_setprio 2
    v_mfma_f32_16x16x32_bf16 v[108:111], v[96:99], v[48:51], 0
    v_cvt_pk_bf16_f32 v114, v92, 0
    v_mov_b32 v115, 0
    ds_read_b128 v[160:163], v14
    s_nop 0
    v_mfma_f32_16x16x32_bf16 v[108:111], v[136:139], v[112:115], v[108:111]
    v_mfma_f32_16x16x32_bf16 v[140:143], v[104:107], v[48:51], 0
    v_mfma_f32_16x16x32_bf16 v[140:143], v[144:147], v[112:115], v[140:143]
    v_mfma_f32_16x16x32_bf16 v[84:87], v[68:71], v[48:51], 0
    s_waitcnt lgkmcnt(0)
    v_add_f32 v163, v160, v161
    v_add_f32 v163, v163, v162
    v_mfma_f32_16x16x32_bf16 v[84:87], v[152:155], v[112:115], v[84:87]
    v_exp_f32 v160, v21
    v_mfma_f32_16x16x32_bf16 v[20:23], v[116:119], v[48:51], 0
    v_cvt_pk_bf16_f32 v108, v108, v109
    v_cvt_pk_bf16_f32 v109, v110, v111
    v_mfma_f32_16x16x32_bf16 v[20:23], v[156:159], v[112:115], v[20:23]
    v_cvt_pk_bf16_f32 v110, v140, v141
    v_cvt_pk_bf16_f32 v111, v142, v143
    v_mfma_f32_16x16x32_bf16 v[72:75], v[80:83], v[48:51], 0
    ds_write_b128 v2, v[108:111] offset:6144
    v_mfma_f32_16x16x32_bf16 v[72:75], v[164:167], v[112:115], v[72:75]
    v_cvt_pk_bf16_f32 v84, v84, v85
    v_cvt_pk_bf16_f32 v85, v86, v87
    v_mfma_f32_16x16x32_bf16 v[140:143], v[120:123], v[48:51], 0
    v_cvt_pk_bf16_f32 v86, v20, v21
    v_cvt_pk_bf16_f32 v87, v22, v23
    v_mfma_f32_16x16x32_bf16 v[140:143], v[148:151], v[112:115], v[140:143]
    ds_write_b128 v2, v[84:87] offset:6208
    s_setprio 0
    v_exp_f32 v161, v77
    v_cvt_pk_bf16_f32 v72, v72, v73
    v_cvt_pk_bf16_f32 v73, v74, v75
    v_exp_f32 v162, v93
    v_exp_f32 v163, v163
    v_add_f32 v20, v160, v161
    v_cndmask_b32 v163, 0, v163, s[56:57]
    v_cvt_pk_bf16_f32 v74, v140, v141
    v_cvt_pk_bf16_f32 v75, v142, v143
    ds_write_b128 v2, v[72:75] offset:6272
    ds_read_b128 v[140:143], v10 offset:6144
    ds_read_b128 v[108:111], v10 offset:7168
    ds_read_b128 v[112:115], v10 offset:8192
    v_add_f32 v20, v20, v162
    v_add_f32 v20, v20, v163
    s_nop 1
    v_add_f32_dpp v20, v20, v20 row_ror:8 row_mask:0xf bank_mask:0xf
    s_nop 1
    v_add_f32_dpp v20, v20, v20 row_ror:4 row_mask:0xf bank_mask:0xf
    s_waitcnt lgkmcnt(2)
    buffer_store_dwordx4 v[140:143], v16, s[16:19], s21 offen sc1 nt
    s_waitcnt lgkmcnt(1)
    buffer_store_dwordx4 v[108:111], v17, s[16:19], s21 offen sc1 nt
    s_waitcnt lgkmcnt(0)
    buffer_store_dwordx4 v[112:115], v18, s[16:19], s21 offen sc1 nt
    s_add_u32 s24, s21, 436608
    v_add_f32_dpp v20, v20, v20 row_ror:2 row_mask:0xf bank_mask:0xf
    s_nop 1
    v_add_f32_dpp v20, v20, v20 row_ror:1 row_mask:0xf bank_mask:0xf
    v_subrev_u32 v21, 0x1f800000, v20
    v_rcp_f32 v20, v20
    v_cmp_le_u32 s[58:59], s52, v21
    v_mul_f32 v160, v160, v20
    v_mul_f32 v161, v161, v20
    v_mul_f32 v162, v162, v20
    v_mul_f32 v163, v163, v20
    s_and_b32 s58, s58, 0xffff
    v_cvt_pk_bf16_f32 v160, v160, v161
    v_cvt_pk_bf16_f32 v162, v162, v163
    ds_write_b16 v12, v160
    ds_write_b16_d16_hi v12, v160 offset:32
    ds_write_b16 v12, v162 offset:64
    ds_write_b16_d16_hi v12, v162 offset:96
    ds_read2_b64 v[20:23], v13 offset0:0 offset1:4
    ds_read2_b64 v[140:143], v13 offset0:8 offset1:12
    s_waitcnt lgkmcnt(1)
    s_setprio 2
    v_mfma_f32_16x16x32_bf16 v[160:163], v[96:99], v[20:23], 0
    s_waitcnt lgkmcnt(0)
    v_mfma_f32_16x16x32_bf16 v[160:163], v[136:139], v[140:143], v[160:163]
    v_mfma_f32_16x16x32_bf16 v[136:139], v[104:107], v[20:23], 0
    v_mfma_f32_16x16x32_bf16 v[136:139], v[144:147], v[140:143], v[136:139]
    v_mfma_f32_16x16x32_bf16 v[144:147], v[68:71], v[20:23], 0
    v_mfma_f32_16x16x32_bf16 v[144:147], v[152:155], v[140:143], v[144:147]
    v_mfma_f32_16x16x32_bf16 v[152:155], v[116:119], v[20:23], 0
    v_mfma_f32_16x16x32_bf16 v[152:155], v[156:159], v[140:143], v[152:155]
    v_mfma_f32_16x16x32_bf16 v[156:159], v[80:83], v[20:23], 0
    s_nop 0
    v_cvt_pk_bf16_f32 v160, v160, v161
    v_mfma_f32_16x16x32_bf16 v[156:159], v[164:167], v[140:143], v[156:159]
    v_cvt_pk_bf16_f32 v161, v162, v163
    v_cvt_pk_bf16_f32 v162, v136, v137
    v_mfma_f32_16x16x32_bf16 v[164:167], v[120:123], v[20:23], 0
    v_cvt_pk_bf16_f32 v163, v138, v139
    v_cvt_pk_bf16_f32 v144, v144, v145
    v_mfma_f32_16x16x32_bf16 v[164:167], v[148:151], v[140:143], v[164:167]
    v_cvt_pk_bf16_f32 v145, v146, v147
    v_cvt_pk_bf16_f32 v146, v152, v153
    s_setprio 0
    v_cvt_pk_bf16_f32 v147, v154, v155
    v_cvt_pk_bf16_f32 v156, v156, v157
    v_cvt_pk_bf16_f32 v157, v158, v159
    s_nop 2
    v_cvt_pk_bf16_f32 v158, v164, v165
    v_cvt_pk_bf16_f32 v159, v166, v167
    s_mov_b32 exec_lo, 0x10001
    s_mov_b32 exec_hi, 0x10001
    buffer_store_dwordx4 v[160:163], v0, s[16:19], s24 offen offset:0 sc1 nt
    buffer_store_dwordx4 v[144:147], v0, s[16:19], s24 offen offset:64 sc1 nt
    buffer_store_dwordx4 v[156:159], v0, s[16:19], s24 offen offset:128 sc1 nt
    s_mov_b64 exec, -1
    s_or_b32 s48, s48, s58
L_chk:
    s_cmp_lg_u64 s[48:49], 0
    s_cbranch_scc1 L_slow
L_fin:
L_end:
    s_endpgm
L_code_end:
L_slow:
    s_waitcnt vmcnt(0) lgkmcnt(0)
    s_nop 7
    s_add_u32 m0, s22, 0
    s_nop 0
    buffer_load_dwordx4 v3, s[8:11], s21 offen nt lds
    s_add_u32 m0, s22, 1024
    s_nop 0
    buffer_load_dwordx4 v4, s[8:11], s21 offen nt lds
    s_add_u32 m0, s22, 2048
    s_nop 0
    buffer_load_dwordx4 v5, s[8:11], s21 offen nt lds
    s_add_u32 m0, s22, 3072
    s_nop 0
    buffer_load_dwordx4 v6, s[8:11], s21 offen nt lds
    s_add_u32 m0, s22, 4096
    s_nop 0
    buffer_load_dwordx4 v7, s[8:11], s21 offen nt lds
    s_add_u32 m0, s22, 5120
    s_nop 0
    buffer_load_dwordx4 v8, s[8:11], s21 offen nt lds
    s_add_u32 m0, s22, 6144
    s_nop 0
    buffer_load_dwordx4 v16, s[8:11], s21 offen nt lds
    s_add_u32 m0, s22, 7168
    s_nop 0
    buffer_load_dwordx4 v17, s[8:11], s21 offen nt lds
    s_add_u32 m0, s22, 8192
    s_nop 0
    buffer_load_dwordx4 v18, s[8:11], s21 offen nt lds
    s_lshr_b32 s23, s20, 2
    s_sub_u32 s23, 0, s23
    s_and_b32 s24, s20, 2
    s_xor_b32 s23, s23, s24
    s_and_b32 s23, s23, 3
    v_lshrrev_b32 v14, 4, v0
    s_mul_i32 s24, s20, 192
    s_add_u32 s24, s24, 64
    v_xor_b32 v14, s23, v14
    v_lshl_add_u32 v14, v14, 4, s24
    s_waitcnt vmcnt(0)
    ds_read_b128 v[20:23], v1 offset:9280
    ds_read_b128 v[24:27], v2 offset:0
    ds_read_b128 v[28:31], v1 offset:10304
    ds_read_b128 v[32:35], v2 offset:64
    ds_read_b128 v[36:39], v1 offset:11328
    ds_read_b128 v[40:43], v2 offset:128
    ds_read_b128 v[44:47], v2 offset:3072
    ds_read_b128 v[48:51], v2 offset:3136
    ds_read_b128 v[52:55], v2 offset:3200
    ds_read_b128 v[56:59], v2 offset:6144
    ds_read_b128 v[60:63], v2 offset:6208
    ds_read_b128 v[64:67], v2 offset:6272
    ds_read_b128 v[68:71], v1 offset:12352
    s_waitcnt lgkmcnt(11)
    v_mfma_f32_16x16x32_bf16 v[72:75], v[20:23], v[24:27], 0
    ds_read_b128 v[76:79], v1 offset:13376
    s_waitcnt lgkmcnt(10)
    v_mfma_f32_16x16x32_bf16 v[72:75], v[28:31], v[32:35], v[72:75]
    ds_read_b128 v[80:83], v1 offset:14400
    s_waitcnt lgkmcnt(9)
    v_mfma_f32_16x16x32_bf16 v[72:75], v[36:39], v[40:43], v[72:75]
    s_waitcnt lgkmcnt(8)
    v_mfma_f32_16x16x32_bf16 v[84:87], v[20:23], v[44:47], 0
    s_waitcnt lgkmcnt(7)
    v_mfma_f32_16x16x32_bf16 v[84:87], v[28:31], v[48:51], v[84:87]
    s_waitcnt lgkmcnt(6)
    v_mfma_f32_16x16x32_bf16 v[84:87], v[36:39], v[52:55], v[84:87]
    s_waitcnt lgkmcnt(5)
    v_mfma_f32_16x16x32_bf16 v[88:91], v[20:23], v[56:59], 0
    v_cvt_pk_bf16_f32 v72, v72, v73
    v_cvt_pk_bf16_f32 v73, v74, v75
    s_waitcnt lgkmcnt(4)
    v_mfma_f32_16x16x32_bf16 v[88:91], v[28:31], v[60:63], v[88:91]
    s_waitcnt lgkmcnt(3)
    v_mfma_f32_16x16x32_bf16 v[88:91], v[36:39], v[64:67], v[88:91]
    ds_read_b128 v[20:23], v1 offset:15424
    s_waitcnt lgkmcnt(3)
    v_mfma_f32_16x16x32_bf16 v[28:31], v[68:71], v[24:27], 0
    ds_read_b128 v[36:39], v1 offset:16448
    s_waitcnt lgkmcnt(3)
    v_mfma_f32_16x16x32_bf16 v[28:31], v[76:79], v[32:35], v[28:31]
    ds_read_b128 v[92:95], v1 offset:17472
    s_waitcnt lgkmcnt(3)
    v_mfma_f32_16x16x32_bf16 v[28:31], v[80:83], v[40:43], v[28:31]
    v_cvt_pk_bf16_f32 v84, v84, v85
    v_cvt_pk_bf16_f32 v85, v86, v87
    v_mfma_f32_16x16x32_bf16 v[96:99], v[68:71], v[44:47], 0
    v_cvt_pk_bf16_f32 v88, v88, v89
    v_cvt_pk_bf16_f32 v89, v90, v91
    v_mfma_f32_16x16x32_bf16 v[96:99], v[76:79], v[48:51], v[96:99]
    v_mfma_f32_16x16x32_bf16 v[96:99], v[80:83], v[52:55], v[96:99]
    s_nop 0
    v_cvt_pk_bf16_f32 v74, v28, v29
    v_mfma_f32_16x16x32_bf16 v[100:103], v[68:71], v[56:59], 0
    v_cvt_pk_bf16_f32 v75, v30, v31
    v_mfma_f32_16x16x32_bf16 v[100:103], v[76:79], v[60:63], v[100:103]
    v_mfma_f32_16x16x32_bf16 v[100:103], v[80:83], v[64:67], v[100:103]
    ds_read_b128 v[68:71], v1 offset:18496
    s_waitcnt lgkmcnt(3)
    v_mfma_f32_16x16x32_bf16 v[28:31], v[20:23], v[24:27], 0
    ds_read_b128 v[76:79], v1 offset:19520
    s_waitcnt lgkmcnt(3)
    v_mfma_f32_16x16x32_bf16 v[28:31], v[36:39], v[32:35], v[28:31]
    ds_read_b128 v[80:83], v1 offset:20544
    s_waitcnt lgkmcnt(3)
    v_mfma_f32_16x16x32_bf16 v[28:31], v[92:95], v[40:43], v[28:31]
    v_cvt_pk_bf16_f32 v86, v96, v97
    v_cvt_pk_bf16_f32 v87, v98, v99
    v_mfma_f32_16x16x32_bf16 v[96:99], v[20:23], v[44:47], 0
    v_cvt_pk_bf16_f32 v90, v100, v101
    v_cvt_pk_bf16_f32 v91, v102, v103
    v_mfma_f32_16x16x32_bf16 v[96:99], v[36:39], v[48:51], v[96:99]
    v_mfma_f32_16x16x32_bf16 v[96:99], v[92:95], v[52:55], v[96:99]
    s_nop 0
    v_cvt_pk_bf16_f32 v28, v28, v29
    v_mfma_f32_16x16x32_bf16 v[100:103], v[20:23], v[56:59], 0
    v_cvt_pk_bf16_f32 v29, v30, v31
    v_mfma_f32_16x16x32_bf16 v[100:103], v[36:39], v[60:63], v[100:103]
    v_mfma_f32_16x16x32_bf16 v[100:103], v[92:95], v[64:67], v[100:103]
    ds_read_b128 v[20:23], v1 offset:21568
    s_waitcnt lgkmcnt(3)
    v_mfma_f32_16x16x32_bf16 v[36:39], v[68:71], v[24:27], 0
    ds_read_b128 v[92:95], v1 offset:22592
    s_waitcnt lgkmcnt(3)
    v_mfma_f32_16x16x32_bf16 v[36:39], v[76:79], v[32:35], v[36:39]
    ds_read_b128 v[104:107], v1 offset:23616
    s_waitcnt lgkmcnt(3)
    v_mfma_f32_16x16x32_bf16 v[36:39], v[80:83], v[40:43], v[36:39]
    v_cvt_pk_bf16_f32 v96, v96, v97
    v_cvt_pk_bf16_f32 v97, v98, v99
    v_mfma_f32_16x16x32_bf16 v[108:111], v[68:71], v[44:47], 0
    v_cvt_pk_bf16_f32 v100, v100, v101
    v_cvt_pk_bf16_f32 v101, v102, v103
    v_mfma_f32_16x16x32_bf16 v[108:111], v[76:79], v[48:51], v[108:111]
    v_mfma_f32_16x16x32_bf16 v[108:111], v[80:83], v[52:55], v[108:111]
    s_nop 0
    v_cvt_pk_bf16_f32 v30, v36, v37
    v_mfma_f32_16x16x32_bf16 v[112:115], v[68:71], v[56:59], 0
    v_cvt_pk_bf16_f32 v31, v38, v39
    v_mfma_f32_16x16x32_bf16 v[112:115], v[76:79], v[60:63], v[112:115]
    v_mfma_f32_16x16x32_bf16 v[112:115], v[80:83], v[64:67], v[112:115]
    ds_read_b128 v[116:119], v1 offset:24640
    s_waitcnt lgkmcnt(3)
    v_mfma_f32_16x16x32_bf16 v[68:71], v[20:23], v[24:27], 0
    ds_read_b128 v[36:39], v1 offset:25664
    s_waitcnt lgkmcnt(3)
    v_mfma_f32_16x16x32_bf16 v[68:71], v[92:95], v[32:35], v[68:71]
    ds_read_b128 v[76:79], v1 offset:26688
    s_waitcnt lgkmcnt(3)
    v_mfma_f32_16x16x32_bf16 v[68:71], v[104:107], v[40:43], v[68:71]
    v_cvt_pk_bf16_f32 v98, v108, v109
    v_cvt_pk_bf16_f32 v99, v110, v111
    v_mfma_f32_16x16x32_bf16 v[80:83], v[20:23], v[44:47], 0
    v_cvt_pk_bf16_f32 v102, v112, v113
    v_cvt_pk_bf16_f32 v103, v114, v115
    v_mfma_f32_16x16x32_bf16 v[80:83], v[92:95], v[48:51], v[80:83]
    v_mfma_f32_16x16x32_bf16 v[80:83], v[104:107], v[52:55], v[80:83]
    s_nop 0
    v_cvt_pk_bf16_f32 v68, v68, v69
    v_mfma_f32_16x16x32_bf16 v[108:111], v[20:23], v[56:59], 0
    v_cvt_pk_bf16_f32 v69, v70, v71
    v_mfma_f32_16x16x32_bf16 v[108:111], v[92:95], v[60:63], v[108:111]
    v_mfma_f32_16x16x32_bf16 v[108:111], v[104:107], v[64:67], v[108:111]
    s_waitcnt lgkmcnt(2)
    v_mfma_f32_16x16x32_bf16 v[20:23], v[116:119], v[24:27], 0
    v_cvt_pk_bf16_f32 v80, v80, v81
    v_cvt_pk_bf16_f32 v81, v82, v83
    s_waitcnt lgkmcnt(1)
    v_mfma_f32_16x16x32_bf16 v[20:23], v[36:39], v[32:35], v[20:23]
    s_waitcnt lgkmcnt(0)
    v_mfma_f32_16x16x32_bf16 v[20:23], v[76:79], v[40:43], v[20:23]
    v_cvt_pk_bf16_f32 v108, v108, v109
    v_cvt_pk_bf16_f32 v109, v110, v111
    v_mfma_f32_16x16x32_bf16 v[92:95], v[116:119], v[44:47], 0
    v_mfma_f32_16x16x32_bf16 v[92:95], v[36:39], v[48:51], v[92:95]
    v_mfma_f32_16x16x32_bf16 v[92:95], v[76:79], v[52:55], v[92:95]
    v_mfma_f32_16x16x32_bf16 v[112:115], v[116:119], v[56:59], 0
    v_mfma_f32_16x16x32_bf16 v[112:115], v[36:39], v[60:63], v[112:115]
    s_nop 0
    v_cvt_pk_bf16_f32 v70, v20, v21
    v_mfma_f32_16x16x32_bf16 v[112:115], v[76:79], v[64:67], v[112:115]
    ds_read_b128 v[36:39], v14 offset:0
    v_mfma_f32_16x16x32_bf16 v[76:79], v[24:27], v[72:75], 0
    ds_read_b128 v[104:107], v14 offset:64
    v_mfma_f32_16x16x32_bf16 v[76:79], v[32:35], v[28:31], v[76:79]
    ds_read_b128 v[116:119], v14 offset:128
    v_cvt_pk_bf16_f32 v71, v22, v23
    v_cvt_pk_bf16_f32 v82, v92, v93
    v_cvt_pk_bf16_f32 v83, v94, v95
    v_mfma_f32_16x16x32_bf16 v[76:79], v[40:43], v[68:71], v[76:79]
    v_cvt_pk_bf16_f32 v110, v112, v113
    v_cvt_pk_bf16_f32 v111, v114, v115
    v_mfma_f32_16x16x32_bf16 v[20:23], v[44:47], v[72:75], 0
    v_mfma_f32_16x16x32_bf16 v[20:23], v[48:51], v[28:31], v[20:23]
    v_mfma_f32_16x16x32_bf16 v[20:23], v[52:55], v[68:71], v[20:23]
    v_mfma_f32_16x16x32_bf16 v[92:95], v[56:59], v[72:75], 0
    v_mfma_f32_16x16x32_bf16 v[92:95], v[60:63], v[28:31], v[92:95]
    v_mfma_f32_16x16x32_bf16 v[92:95], v[64:67], v[68:71], v[92:95]
    s_waitcnt lgkmcnt(2)
    v_mfma_f32_16x16x32_bf16 v[112:115], v[36:39], v[72:75], 0
    s_waitcnt lgkmcnt(1)
    v_mfma_f32_16x16x32_bf16 v[112:115], v[104:107], v[28:31], v[112:115]
    s_waitcnt lgkmcnt(0)
    v_mfma_f32_16x16x32_bf16 v[112:115], v[116:119], v[68:71], v[112:115]
    v_mfma_f32_16x16x32_bf16 v[72:75], v[24:27], v[84:87], 0
    v_mfma_f32_16x16x32_bf16 v[72:75], v[32:35], v[96:99], v[72:75]
    v_mfma_f32_16x16x32_bf16 v[72:75], v[40:43], v[80:83], v[72:75]
    v_mfma_f32_16x16x32_bf16 v[28:31], v[44:47], v[84:87], 0
    v_mfma_f32_16x16x32_bf16 v[28:31], v[48:51], v[96:99], v[28:31]
    v_mfma_f32_16x16x32_bf16 v[28:31], v[52:55], v[80:83], v[28:31]
    v_mfma_f32_16x16x32_bf16 v[68:71], v[56:59], v[84:87], 0
    s_nop 0
    v_max3_f32 v114, v76, v77, v78
    v_mfma_f32_16x16x32_bf16 v[68:71], v[60:63], v[96:99], v[68:71]
    v_max3_f32 v115, v79, v20, v21
    v_max3_f32 v114, v114, v22, v23
    v_mfma_f32_16x16x32_bf16 v[68:71], v[64:67], v[80:83], v[68:71]
    v_max3_f32 v115, v115, v92, v93
    v_max3_f32 v114, v114, v94, v95
    v_mfma_f32_16x16x32_bf16 v[120:123], v[36:39], v[84:87], 0
    v_max3_f32 v114, v114, v115, v112
    v_mfma_f32_16x16x32_bf16 v[120:123], v[104:107], v[96:99], v[120:123]
    v_mfma_f32_16x16x32_bf16 v[120:123], v[116:119], v[80:83], v[120:123]
    v_mfma_f32_16x16x32_bf16 v[96:99], v[24:27], v[88:91], 0
    v_mfma_f32_16x16x32_bf16 v[96:99], v[32:35], v[100:103], v[96:99]
    v_mfma_f32_16x16x32_bf16 v[96:99], v[40:43], v[108:111], v[96:99]
    ds_read_b128 v[84:87], v1 offset:3136
    v_mfma_f32_16x16x32_bf16 v[80:83], v[44:47], v[88:91], 0
    ds_read_b128 v[124:127], v1 offset:4160
    v_mfma_f32_16x16x32_bf16 v[80:83], v[48:51], v[100:103], v[80:83]
    ds_read_b128 v[128:131], v1 offset:5184
    v_mfma_f32_16x16x32_bf16 v[80:83], v[52:55], v[108:111], v[80:83]
    v_max3_f32 v122, v72, v73, v74
    v_max3_f32 v123, v75, v28, v29
    v_mfma_f32_16x16x32_bf16 v[132:135], v[56:59], v[88:91], 0
    v_max3_f32 v122, v122, v30, v31
    v_max3_f32 v123, v123, v68, v69
    v_mfma_f32_16x16x32_bf16 v[132:135], v[60:63], v[100:103], v[132:135]
    v_max3_f32 v122, v122, v70, v71
    v_max3_f32 v122, v122, v123, v120
    v_mfma_f32_16x16x32_bf16 v[132:135], v[64:67], v[108:111], v[132:135]
    s_nop 0
    v_permlane32_swap_b32 v114, v122
    v_mfma_f32_16x16x32_bf16 v[136:139], v[36:39], v[88:91], 0
    v_max_f32 v114, v114, v122
    v_mov_b32 v122, v114
    v_mfma_f32_16x16x32_bf16 v[136:139], v[104:107], v[100:103], v[136:139]
    s_nop 0
    v_permlane16_swap_b32 v114, v122
    v_mfma_f32_16x16x32_bf16 v[136:139], v[116:119], v[108:111], v[136:139]
    v_max_f32 v114, v114, v122
    v_mov_b32 v122, v114
    s_waitcnt lgkmcnt(2)
    v_mfma_f32_16x16x32_bf16 v[108:111], v[24:27], v[84:87], 0
    v_permlane32_swap_b32 v114, v122
    s_waitcnt lgkmcnt(1)
    v_mfma_f32_16x16x32_bf16 v[108:111], v[32:35], v[124:127], v[108:111]
    v_sub_f32 v76, v76, v114
    v_sub_f32 v77, v77, v114
    s_waitcnt lgkmcnt(0)
    v_mfma_f32_16x16x32_bf16 v[108:111], v[40:43], v[128:131], v[108:111]
    ds_read_b128 v[88:91], v1 offset:27712
    v_mfma_f32_16x16x32_bf16 v[100:103], v[44:47], v[84:87], 0
    ds_read_b128 v[140:143], v1 offset:28736
    v_mfma_f32_16x16x32_bf16 v[100:103], v[48:51], v[124:127], v[100:103]
    ds_read_b128 v[144:147], v1 offset:29760
    v_mfma_f32_16x16x32_bf16 v[100:103], v[52:55], v[128:131], v[100:103]
    v_sub_f32 v78, v78, v114
    v_sub_f32 v79, v79, v114
    v_mfma_f32_16x16x32_bf16 v[148:151], v[56:59], v[84:87], 0
    v_sub_f32 v20, v20, v114
    v_sub_f32 v21, v21, v114
    v_mfma_f32_16x16x32_bf16 v[148:151], v[60:63], v[124:127], v[148:151]
    v_sub_f32 v22, v22, v114
    v_sub_f32 v23, v23, v114
    v_mfma_f32_16x16x32_bf16 v[148:151], v[64:67], v[128:131], v[148:151]
    v_sub_f32 v92, v92, v114
    v_sub_f32 v93, v93, v114
    v_mfma_f32_16x16x32_bf16 v[152:155], v[36:39], v[84:87], 0
    v_sub_f32 v94, v94, v114
    v_sub_f32 v95, v95, v114
    v_mfma_f32_16x16x32_bf16 v[152:155], v[104:107], v[124:127], v[152:155]
    v_sub_f32 v112, v112, v114
    v_sub_f32 v72, v72, v122
    v_mfma_f32_16x16x32_bf16 v[152:155], v[116:119], v[128:131], v[152:155]
    ds_read_b128 v[36:39], v1 offset:30784
    s_waitcnt lgkmcnt(3)
    v_mfma_f32_16x16x32_bf16 v[84:87], v[24:27], v[88:91], 0
    ds_read_b128 v[104:107], v1 offset:31808
    s_waitcnt lgkmcnt(3)
    v_mfma_f32_16x16x32_bf16 v[84:87], v[32:35], v[140:143], v[84:87]
    ds_read_b128 v[116:119], v1 offset:32832
    s_waitcnt lgkmcnt(3)
    v_mfma_f32_16x16x32_bf16 v[84:87], v[40:43], v[144:147], v[84:87]
    v_sub_f32 v73, v73, v122
    v_sub_f32 v74, v74, v122
    v_mfma_f32_16x16x32_bf16 v[124:127], v[44:47], v[88:91], 0
    v_sub_f32 v75, v75, v122
    v_sub_f32 v28, v28, v122
    v_mfma_f32_16x16x32_bf16 v[124:127], v[48:51], v[140:143], v[124:127]
    v_sub_f32 v29, v29, v122
    v_sub_f32 v30, v30, v122
    v_mfma_f32_16x16x32_bf16 v[124:127], v[52:55], v[144:147], v[124:127]
    v_cvt_pk_bf16_f32 v84, v84, v85
    v_cvt_pk_bf16_f32 v85, v86, v87
    v_mfma_f32_16x16x32_bf16 v[128:131], v[56:59], v[88:91], 0
    v_sub_f32 v31, v31, v122
    v_sub_f32 v68, v68, v122
    v_mfma_f32_16x16x32_bf16 v[128:131], v[60:63], v[140:143], v[128:131]
    v_sub_f32 v69, v69, v122
    v_sub_f32 v70, v70, v122
    v_mfma_f32_16x16x32_bf16 v[128:131], v[64:67], v[144:147], v[128:131]
    ds_read_b128 v[88:91], v1 offset:33856
    s_waitcnt lgkmcnt(3)
    v_mfma_f32_16x16x32_bf16 v[140:143], v[24:27], v[36:39], 0
    ds_read_b128 v[144:147], v1 offset:34880
    s_waitcnt lgkmcnt(3)
    v_mfma_f32_16x16x32_bf16 v[140:143], v[32:35], v[104:107], v[140:143]
    v_cvt_pk_bf16_f32 v86, v124, v125
    v_cvt_pk_bf16_f32 v87, v126, v127
    ds_read_b128 v[124:127], v1 offset:35904
    s_waitcnt lgkmcnt(3)
    v_mfma_f32_16x16x32_bf16 v[140:143], v[40:43], v[116:119], v[140:143]
    v_cvt_pk_bf16_f32 v128, v128, v129
    v_cvt_pk_bf16_f32 v129, v130, v131
    v_mfma_f32_16x16x32_bf16 v[156:159], v[44:47], v[36:39], 0
    v_sub_f32 v71, v71, v122
    v_sub_f32 v120, v120, v122
    v_mfma_f32_16x16x32_bf16 v[156:159], v[48:51], v[104:107], v[156:159]
    v_exp_f32 v76, v76
    v_mfma_f32_16x16x32_bf16 v[156:159], v[52:55], v[116:119], v[156:159]
    v_cvt_pk_bf16_f32 v140, v140, v141
    v_cvt_pk_bf16_f32 v141, v142, v143
    v_mfma_f32_16x16x32_bf16 v[160:163], v[56:59], v[36:39], 0
    v_exp_f32 v77, v77
    v_mfma_f32_16x16x32_bf16 v[160:163], v[60:63], v[104:107], v[160:163]
    v_exp_f32 v78, v78
    v_mfma_f32_16x16x32_bf16 v[160:163], v[64:67], v[116:119], v[160:163]
    ds_read_b128 v[164:167], v1 offset:36928
    s_waitcnt lgkmcnt(3)
    v_mfma_f32_16x16x32_bf16 v[36:39], v[24:27], v[88:91], 0
    v_cvt_pk_bf16_f32 v142, v156, v157
    v_cvt_pk_bf16_f32 v143, v158, v159
    s_waitcnt lgkmcnt(2)
    v_mfma_f32_16x16x32_bf16 v[36:39], v[32:35], v[144:147], v[36:39]
    v_exp_f32 v79, v79
    s_waitcnt lgkmcnt(1)
    v_mfma_f32_16x16x32_bf16 v[36:39], v[40:43], v[124:127], v[36:39]
    v_cvt_pk_bf16_f32 v160, v160, v161
    v_cvt_pk_bf16_f32 v161, v162, v163
    v_mfma_f32_16x16x32_bf16 v[156:159], v[44:47], v[88:91], 0
    v_exp_f32 v20, v20
    v_mfma_f32_16x16x32_bf16 v[156:159], v[48:51], v[144:147], v[156:159]
    v_exp_f32 v21, v21
    v_mfma_f32_16x16x32_bf16 v[156:159], v[52:55], v[124:127], v[156:159]
    v_exp_f32 v22, v22
    v_mfma_f32_16x16x32_bf16 v[104:107], v[56:59], v[88:91], 0
    v_cvt_pk_bf16_f32 v36, v36, v37
    v_cvt_pk_bf16_f32 v37, v38, v39
    v_mfma_f32_16x16x32_bf16 v[104:107], v[60:63], v[144:147], v[104:107]
    v_exp_f32 v23, v23
    v_mfma_f32_16x16x32_bf16 v[104:107], v[64:67], v[124:127], v[104:107]
    ds_read_b128 v[116:119], v1 offset:37952
    s_waitcnt lgkmcnt(1)
    v_mfma_f32_16x16x32_bf16 v[88:91], v[24:27], v[164:167], 0
    v_cvt_pk_bf16_f32 v38, v156, v157
    v_cvt_pk_bf16_f32 v39, v158, v159
    v_exp_f32 v92, v92
    v_exp_f32 v93, v93
    v_exp_f32 v94, v94
    v_cvt_pk_bf16_f32 v104, v104, v105
    v_cvt_pk_bf16_f32 v105, v106, v107
    v_exp_f32 v95, v95
    v_exp_f32 v112, v112
    v_add_f32 v115, v76, v77
    v_cndmask_b32 v112, 0, v112, s[34:35]
    v_add_f32 v114, v112, v78
    v_add_f32 v115, v115, v79
    v_add_f32 v114, v114, v20
    v_add_f32 v115, v115, v21
    v_add_f32 v114, v114, v22
    v_add_f32 v115, v115, v23
    v_add_f32 v114, v114, v92
    v_add_f32 v115, v115, v93
    v_add_f32 v114, v114, v94
    s_waitcnt lgkmcnt(0)
    v_mfma_f32_16x16x32_bf16 v[88:91], v[32:35], v[116:119], v[88:91]
    ds_read_b128 v[144:147], v1 offset:38976
    v_add_f32 v115, v115, v95
    v_add_f32 v114, v114, v115
    v_exp_f32 v72, v72
    v_exp_f32 v73, v73
    v_exp_f32 v74, v74
    v_exp_f32 v75, v75
    v_exp_f32 v28, v28
    v_exp_f32 v29, v29
    v_exp_f32 v30, v30
    v_exp_f32 v31, v31
    v_exp_f32 v68, v68
    v_exp_f32 v69, v69
    v_exp_f32 v70, v70
    v_exp_f32 v71, v71
    v_exp_f32 v120, v120
    s_waitcnt lgkmcnt(0)
    v_mfma_f32_16x16x32_bf16 v[88:91], v[40:43], v[144:147], v[88:91]
    v_add_f32 v123, v72, v73
    v_cndmask_b32 v120, 0, v120, s[34:35]
    v_mfma_f32_16x16x32_bf16 v[124:127], v[44:47], v[164:167], 0
    v_add_f32 v122, v120, v74
    v_add_f32 v123, v123, v75
    v_mfma_f32_16x16x32_bf16 v[124:127], v[48:51], v[116:119], v[124:127]
    v_add_f32 v122, v122, v28
    v_add_f32 v123, v123, v29
    v_mfma_f32_16x16x32_bf16 v[124:127], v[52:55], v[144:147], v[124:127]
    v_cvt_pk_bf16_f32 v88, v88, v89
    v_cvt_pk_bf16_f32 v89, v90, v91
    v_mfma_f32_16x16x32_bf16 v[156:159], v[56:59], v[164:167], 0
    v_add_f32 v122, v122, v30
    v_add_f32 v123, v123, v31
    v_mfma_f32_16x16x32_bf16 v[156:159], v[60:63], v[116:119], v[156:159]
    v_add_f32 v122, v122, v68
    v_add_f32 v123, v123, v69
    v_mfma_f32_16x16x32_bf16 v[156:159], v[64:67], v[144:147], v[156:159]
    ds_read_b128 v[164:167], v1 offset:40000
    v_cvt_pk_bf16_f32 v90, v124, v125
    v_cvt_pk_bf16_f32 v91, v126, v127
    v_add_f32 v122, v122, v70
    v_add_f32 v123, v123, v71
    v_add_f32 v122, v122, v123
    s_nop 1
    v_cvt_pk_bf16_f32 v156, v156, v157
    v_cvt_pk_bf16_f32 v157, v158, v159
    v_permlane32_swap_b32 v114, v122
    v_add_f32 v114, v114, v122
    v_mov_b32 v122, v114
    s_nop 1
    v_permlane16_swap_b32 v114, v122
    v_add_f32 v114, v114, v122
    v_rcp_f32 v114, v114
    s_nop 0
    v_mov_b32 v122, v114
    s_nop 1
    v_permlane32_swap_b32 v114, v122
    v_mul_f32 v76, v76, v114
    s_waitcnt lgkmcnt(0)
    v_mfma_f32_16x16x32_bf16 v[116:119], v[24:27], v[164:167], 0
    ds_read_b128 v[144:147], v1 offset:41024
    v_mul_f32 v77, v77, v114
    v_mul_f32 v78, v78, v114
    v_mul_f32 v79, v79, v114
    v_mul_f32 v20, v20, v114
    v_mul_f32 v21, v21, v114
    v_mul_f32 v22, v22, v114
    v_mul_f32 v23, v23, v114
    v_mul_f32 v92, v92, v114
    v_mul_f32 v93, v93, v114
    v_mul_f32 v94, v94, v114
    v_mul_f32 v95, v95, v114
    v_mul_f32 v112, v112, v114
    v_cvt_pk_bf16_f32 v76, v76, v77
    v_cvt_pk_bf16_f32 v77, v78, v79
    v_cvt_pk_bf16_f32 v78, v20, v21
    v_cvt_pk_bf16_f32 v79, v22, v23
    v_cvt_pk_bf16_f32 v92, v92, v93
    v_cvt_pk_bf16_f32 v93, v94, v95
    v_cvt_pk_bf16_f32 v94, v112, 0
    v_mov_b32 v95, 0
    v_mul_f32 v72, v72, v122
    v_mul_f32 v73, v73, v122
    v_mul_f32 v74, v74, v122
    v_mul_f32 v75, v75, v122
    v_mul_f32 v28, v28, v122
    v_mul_f32 v29, v29, v122
    v_mul_f32 v30, v30, v122
    s_waitcnt lgkmcnt(0)
    v_mfma_f32_16x16x32_bf16 v[116:119], v[32:35], v[144:147], v[116:119]
    ds_read_b128 v[20:23], v1 offset:42048
    v_mul_f32 v31, v31, v122
    v_mul_f32 v68, v68, v122
    v_mul_f32 v69, v69, v122
    v_mul_f32 v70, v70, v122
    v_mul_f32 v71, v71, v122
    v_mul_f32 v120, v120, v122
    v_cvt_pk_bf16_f32 v72, v72, v73
    v_cvt_pk_bf16_f32 v73, v74, v75
    v_cvt_pk_bf16_f32 v74, v28, v29
    v_cvt_pk_bf16_f32 v75, v30, v31
    v_cvt_pk_bf16_f32 v68, v68, v69
    v_cvt_pk_bf16_f32 v69, v70, v71
    v_cvt_pk_bf16_f32 v70, v120, 0
    ds_read_b128 v[112:115], v1 offset:43072
    v_mov_b32 v71, 0
    v_max3_f32 v138, v96, v97, v98
    v_max3_f32 v139, v99, v80, v81
    v_max3_f32 v138, v138, v82, v83
    v_max3_f32 v139, v139, v132, v133
    v_max3_f32 v138, v138, v134, v135
    v_max3_f32 v138, v138, v139, v136
    v_max3_f32 v154, v108, v109, v110
    v_max3_f32 v155, v111, v100, v101
    v_max3_f32 v154, v154, v102, v103
    v_max3_f32 v155, v155, v148, v149
    s_waitcnt lgkmcnt(1)
    v_mfma_f32_16x16x32_bf16 v[116:119], v[40:43], v[20:23], v[116:119]
    v_max3_f32 v154, v154, v150, v151
    v_max3_f32 v154, v154, v155, v152
    v_mfma_f32_16x16x32_bf16 v[28:31], v[44:47], v[164:167], 0
    s_nop 0
    v_permlane32_swap_b32 v138, v154
    v_mfma_f32_16x16x32_bf16 v[28:31], v[48:51], v[144:147], v[28:31]
    v_max_f32 v138, v138, v154
    v_mov_b32 v154, v138
    v_mfma_f32_16x16x32_bf16 v[28:31], v[52:55], v[20:23], v[28:31]
    v_cvt_pk_bf16_f32 v116, v116, v117
    v_cvt_pk_bf16_f32 v117, v118, v119
    v_mfma_f32_16x16x32_bf16 v[124:127], v[56:59], v[164:167], 0
    v_permlane16_swap_b32 v138, v154
    v_mfma_f32_16x16x32_bf16 v[124:127], v[60:63], v[144:147], v[124:127]
    v_max_f32 v138, v138, v154
    v_mov_b32 v154, v138
    v_mfma_f32_16x16x32_bf16 v[124:127], v[64:67], v[20:23], v[124:127]
    ds_read_b128 v[20:23], v1 offset:44096
    s_waitcnt lgkmcnt(1)
    v_mfma_f32_16x16x32_bf16 v[120:123], v[24:27], v[112:115], 0
    v_cvt_pk_bf16_f32 v118, v28, v29
    v_cvt_pk_bf16_f32 v119, v30, v31
    ds_read_b128 v[164:167], v1 offset:45120
    ds_read2st64_b32 v[130:131], v9 offset0:0 offset1:0
    v_permlane32_swap_b32 v138, v154
    v_cvt_pk_bf16_f32 v124, v124, v125
    v_cvt_pk_bf16_f32 v125, v126, v127
    v_sub_f32 v96, v96, v138
    v_sub_f32 v97, v97, v138
    v_sub_f32 v98, v98, v138
    v_sub_f32 v99, v99, v138
    v_sub_f32 v80, v80, v138
    v_sub_f32 v81, v81, v138
    v_sub_f32 v82, v82, v138
    v_sub_f32 v83, v83, v138
    v_sub_f32 v132, v132, v138
    v_sub_f32 v133, v133, v138
    v_sub_f32 v134, v134, v138
    v_sub_f32 v135, v135, v138
    v_sub_f32 v136, v136, v138
    s_waitcnt lgkmcnt(2)
    v_mfma_f32_16x16x32_bf16 v[120:123], v[32:35], v[20:23], v[120:123]
    v_sub_f32 v108, v108, v154
    v_sub_f32 v109, v109, v154
    v_sub_f32 v110, v110, v154
    v_sub_f32 v111, v111, v154
    v_sub_f32 v100, v100, v154
    s_waitcnt lgkmcnt(1)
    v_mfma_f32_16x16x32_bf16 v[120:123], v[40:43], v[164:167], v[120:123]
    ds_read2st64_b32 v[162:163], v9 offset0:3 offset1:3
    v_mfma_f32_16x16x32_bf16 v[144:147], v[44:47], v[112:115], 0
    v_sub_f32 v101, v101, v154
    v_sub_f32 v102, v102, v154
    v_mfma_f32_16x16x32_bf16 v[144:147], v[48:51], v[20:23], v[144:147]
    ds_read2st64_b32 v[106:107], v9 offset0:6 offset1:6
    v_mfma_f32_16x16x32_bf16 v[144:147], v[52:55], v[164:167], v[144:147]
    v_sub_f32 v103, v103, v154
    v_cvt_pk_bf16_f32 v120, v120, v121
    v_mfma_f32_16x16x32_bf16 v[24:27], v[56:59], v[112:115], 0
    ds_read2st64_b32 v[158:159], v9 offset0:9 offset1:9
    v_mfma_f32_16x16x32_bf16 v[24:27], v[60:63], v[20:23], v[24:27]
    v_cvt_pk_bf16_f32 v121, v122, v123
    v_sub_f32 v148, v148, v154
    v_mfma_f32_16x16x32_bf16 v[24:27], v[64:67], v[164:167], v[24:27]
    ds_read2st64_b32 v[126:127], v9 offset0:12 offset1:12
    v_mfma_f32_16x16x32_bf16 v[20:23], v[84:87], v[76:79], 0
    v_cvt_pk_bf16_f32 v122, v144, v145
    v_cvt_pk_bf16_f32 v123, v146, v147
    s_waitcnt lgkmcnt(4)
    v_mfma_f32_16x16x32_bf16 v[20:23], v[128:131], v[92:95], v[20:23]
    v_sub_f32 v149, v149, v154
    v_sub_f32 v150, v150, v154
    v_mfma_f32_16x16x32_bf16 v[112:115], v[140:143], v[76:79], 0
    v_cvt_pk_bf16_f32 v24, v24, v25
    v_cvt_pk_bf16_f32 v25, v26, v27
    ds_read2st64_b32 v[26:27], v9 offset0:15 offset1:15
    s_waitcnt lgkmcnt(4)
    v_mfma_f32_16x16x32_bf16 v[112:115], v[160:163], v[92:95], v[112:115]
    v_cvt_pk_bf16_f32 v20, v20, v21
    v_cvt_pk_bf16_f32 v21, v22, v23
    v_mfma_f32_16x16x32_bf16 v[164:167], v[36:39], v[76:79], 0
    v_sub_f32 v151, v151, v154
    v_sub_f32 v152, v152, v154
    s_waitcnt lgkmcnt(3)
    v_mfma_f32_16x16x32_bf16 v[164:167], v[104:107], v[92:95], v[164:167]
    v_exp_f32 v96, v96
    v_mfma_f32_16x16x32_bf16 v[144:147], v[88:91], v[76:79], 0
    v_cvt_pk_bf16_f32 v22, v112, v113
    v_cvt_pk_bf16_f32 v23, v114, v115
    s_waitcnt lgkmcnt(2)
    v_mfma_f32_16x16x32_bf16 v[144:147], v[156:159], v[92:95], v[144:147]
    ds_write_b128 v2, v[20:23] offset:0
    v_mfma_f32_16x16x32_bf16 v[20:23], v[116:119], v[76:79], 0
    v_cvt_pk_bf16_f32 v164, v164, v165
    v_cvt_pk_bf16_f32 v165, v166, v167
    s_waitcnt lgkmcnt(2)
    v_mfma_f32_16x16x32_bf16 v[20:23], v[124:127], v[92:95], v[20:23]
    v_exp_f32 v97, v97
    v_mfma_f32_16x16x32_bf16 v[112:115], v[120:123], v[76:79], 0
    v_cvt_pk_bf16_f32 v166, v144, v145
    v_cvt_pk_bf16_f32 v167, v146, v147
    s_waitcnt lgkmcnt(1)
    v_mfma_f32_16x16x32_bf16 v[112:115], v[24:27], v[92:95], v[112:115]
    ds_write_b128 v2, v[164:167] offset:64
    v_mfma_f32_16x16x32_bf16 v[76:79], v[84:87], v[72:75], 0
    v_cvt_pk_bf16_f32 v20, v20, v21
    v_cvt_pk_bf16_f32 v21, v22, v23
    v_mfma_f32_16x16x32_bf16 v[76:79], v[128:131], v[68:71], v[76:79]
    v_exp_f32 v98, v98
    v_mfma_f32_16x16x32_bf16 v[144:147], v[140:143], v[72:75], 0
    v_exp_f32 v99, v99
    v_mfma_f32_16x16x32_bf16 v[144:147], v[160:163], v[68:71], v[144:147]
    v_cvt_pk_bf16_f32 v22, v112, v113
    v_cvt_pk_bf16_f32 v23, v114, v115
    v_mfma_f32_16x16x32_bf16 v[92:95], v[36:39], v[72:75], 0
    ds_write_b128 v2, v[20:23] offset:128
    v_mfma_f32_16x16x32_bf16 v[92:95], v[104:107], v[68:71], v[92:95]
    ds_read_b128 v[20:23], v10 offset:0
    v_mfma_f32_16x16x32_bf16 v[164:167], v[88:91], v[72:75], 0
    ds_read_b128 v[112:115], v10 offset:1024
    v_mfma_f32_16x16x32_bf16 v[164:167], v[156:159], v[68:71], v[164:167]
    ds_read_b128 v[28:31], v10 offset:2048
    v_mfma_f32_16x16x32_bf16 v[32:35], v[116:119], v[72:75], 0
    v_cvt_pk_bf16_f32 v76, v76, v77
    v_cvt_pk_bf16_f32 v77, v78, v79
    v_mfma_f32_16x16x32_bf16 v[32:35], v[124:127], v[68:71], v[32:35]
    v_cvt_pk_bf16_f32 v78, v144, v145
    v_cvt_pk_bf16_f32 v79, v146, v147
    v_mfma_f32_16x16x32_bf16 v[144:147], v[120:123], v[72:75], 0
    v_cvt_pk_bf16_f32 v92, v92, v93
    v_cvt_pk_bf16_f32 v93, v94, v95
    v_mfma_f32_16x16x32_bf16 v[144:147], v[24:27], v[68:71], v[144:147]
    v_cvt_pk_bf16_f32 v94, v164, v165
    v_cvt_pk_bf16_f32 v95, v166, v167
    v_cvt_pk_bf16_f32 v32, v32, v33
    s_waitcnt lgkmcnt(2)
    buffer_store_dwordx4 v[20:23], v3, s[16:19], s21 offen sc1 nt
    s_waitcnt lgkmcnt(1)
    buffer_store_dwordx4 v[112:115], v4, s[16:19], s21 offen sc1 nt
    s_waitcnt lgkmcnt(0)
    buffer_store_dwordx4 v[28:31], v5, s[16:19], s21 offen sc1 nt
    ds_write_b128 v2, v[76:79] offset:3072
    ds_write_b128 v2, v[92:95] offset:3136
    v_cvt_pk_bf16_f32 v33, v34, v35
    v_cvt_pk_bf16_f32 v34, v144, v145
    v_cvt_pk_bf16_f32 v35, v146, v147
    ds_write_b128 v2, v[32:35] offset:3200
    ds_read_b128 v[20:23], v10 offset:3072
    ds_read_b128 v[164:167], v10 offset:4096
    ds_read_b128 v[112:115], v10 offset:5120
    v_exp_f32 v80, v80
    v_exp_f32 v81, v81
    v_exp_f32 v82, v82
    v_exp_f32 v83, v83
    v_exp_f32 v132, v132
    v_exp_f32 v133, v133
    v_exp_f32 v134, v134
    v_exp_f32 v135, v135
    v_exp_f32 v136, v136
    v_add_f32 v139, v96, v97
    v_cndmask_b32 v136, 0, v136, s[34:35]
    v_add_f32 v138, v136, v98
    s_waitcnt lgkmcnt(2)
    buffer_store_dwordx4 v[20:23], v6, s[16:19], s21 offen sc1 nt
    s_waitcnt lgkmcnt(1)
    buffer_store_dwordx4 v[164:167], v7, s[16:19], s21 offen sc1 nt
    s_waitcnt lgkmcnt(0)
    buffer_store_dwordx4 v[112:115], v8, s[16:19], s21 offen sc1 nt
    v_add_f32 v139, v139, v99
    v_add_f32 v138, v138, v80
    v_add_f32 v139, v139, v81
    v_add_f32 v138, v138, v82
    v_add_f32 v139, v139, v83
    v_add_f32 v138, v138, v132
    v_add_f32 v139, v139, v133
    v_add_f32 v138, v138, v134
    v_add_f32 v139, v139, v135
    v_add_f32 v138, v138, v139
    v_exp_f32 v108, v108
    v_exp_f32 v109, v109
    v_exp_f32 v110, v110
    v_exp_f32 v111, v111
    v_exp_f32 v100, v100
    v_exp_f32 v101, v101
    v_exp_f32 v102, v102
    v_exp_f32 v103, v103
    v_exp_f32 v148, v148
    v_exp_f32 v149, v149
    v_exp_f32 v150, v150
    v_exp_f32 v151, v151
    v_exp_f32 v152, v152
    v_add_f32 v155, v108, v109
    v_cndmask_b32 v152, 0, v152, s[34:35]
    v_add_f32 v154, v152, v110
    v_add_f32 v155, v155, v111
    v_add_f32 v154, v154, v100
    v_add_f32 v155, v155, v101
    v_add_f32 v154, v154, v102
    v_add_f32 v155, v155, v103
    v_add_f32 v154, v154, v148
    v_add_f32 v155, v155, v149
    v_add_f32 v154, v154, v150
    v_add_f32 v155, v155, v151
    v_add_f32 v154, v154, v155
    s_nop 1
    v_permlane32_swap_b32 v138, v154
    v_add_f32 v138, v138, v154
    v_mov_b32 v154, v138
    s_nop 1
    v_permlane16_swap_b32 v138, v154
    v_add_f32 v138, v138, v154
    v_rcp_f32 v138, v138
    s_nop 0
    v_mov_b32 v154, v138
    s_nop 1
    v_permlane32_swap_b32 v138, v154
    v_mul_f32 v96, v96, v138
    v_mul_f32 v97, v97, v138
    v_mul_f32 v98, v98, v138
    v_mul_f32 v99, v99, v138
    v_mul_f32 v80, v80, v138
    v_mul_f32 v81, v81, v138
    v_mul_f32 v82, v82, v138
    v_mul_f32 v83, v83, v138
    v_mul_f32 v132, v132, v138
    v_mul_f32 v133, v133, v138
    v_mul_f32 v134, v134, v138
    v_mul_f32 v135, v135, v138
    v_mul_f32 v136, v136, v138
    v_cvt_pk_bf16_f32 v96, v96, v97
    v_cvt_pk_bf16_f32 v97, v98, v99
    v_cvt_pk_bf16_f32 v98, v80, v81
    v_cvt_pk_bf16_f32 v99, v82, v83
    v_cvt_pk_bf16_f32 v132, v132, v133
    v_cvt_pk_bf16_f32 v133, v134, v135
    v_mfma_f32_16x16x32_bf16 v[20:23], v[84:87], v[96:99], 0
    v_cvt_pk_bf16_f32 v134, v136, 0
    v_mov_b32 v135, 0
    v_mul_f32 v108, v108, v154
    v_mul_f32 v109, v109, v154
    v_mfma_f32_16x16x32_bf16 v[20:23], v[128:131], v[132:135], v[20:23]
    v_mul_f32 v110, v110, v154
    v_mul_f32 v111, v111, v154
    v_mfma_f32_16x16x32_bf16 v[92:95], v[140:143], v[96:99], 0
    v_mul_f32 v100, v100, v154
    v_mul_f32 v101, v101, v154
    v_mfma_f32_16x16x32_bf16 v[92:95], v[160:163], v[132:135], v[92:95]
    v_mul_f32 v102, v102, v154
    v_mul_f32 v103, v103, v154
    v_mfma_f32_16x16x32_bf16 v[164:167], v[36:39], v[96:99], 0
    v_cvt_pk_bf16_f32 v20, v20, v21
    v_cvt_pk_bf16_f32 v21, v22, v23
    v_mfma_f32_16x16x32_bf16 v[164:167], v[104:107], v[132:135], v[164:167]
    v_mul_f32 v148, v148, v154
    v_mul_f32 v149, v149, v154
    v_mfma_f32_16x16x32_bf16 v[112:115], v[88:91], v[96:99], 0
    v_cvt_pk_bf16_f32 v22, v92, v93
    v_cvt_pk_bf16_f32 v23, v94, v95
    v_mfma_f32_16x16x32_bf16 v[112:115], v[156:159], v[132:135], v[112:115]
    ds_write_b128 v2, v[20:23] offset:6144
    v_mfma_f32_16x16x32_bf16 v[20:23], v[116:119], v[96:99], 0
    v_cvt_pk_bf16_f32 v164, v164, v165
    v_cvt_pk_bf16_f32 v165, v166, v167
    v_mfma_f32_16x16x32_bf16 v[20:23], v[124:127], v[132:135], v[20:23]
    v_mul_f32 v150, v150, v154
    v_mul_f32 v151, v151, v154
    v_mfma_f32_16x16x32_bf16 v[92:95], v[120:123], v[96:99], 0
    v_cvt_pk_bf16_f32 v166, v112, v113
    v_cvt_pk_bf16_f32 v167, v114, v115
    v_mfma_f32_16x16x32_bf16 v[92:95], v[24:27], v[132:135], v[92:95]
    ds_write_b128 v2, v[164:167] offset:6208
    v_mul_f32 v152, v152, v154
    v_cvt_pk_bf16_f32 v20, v20, v21
    v_cvt_pk_bf16_f32 v21, v22, v23
    v_cvt_pk_bf16_f32 v108, v108, v109
    v_cvt_pk_bf16_f32 v109, v110, v111
    v_cvt_pk_bf16_f32 v110, v100, v101
    v_cvt_pk_bf16_f32 v111, v102, v103
    v_cvt_pk_bf16_f32 v22, v92, v93
    v_cvt_pk_bf16_f32 v23, v94, v95
    v_mfma_f32_16x16x32_bf16 v[112:115], v[84:87], v[108:111], 0
    ds_write_b128 v2, v[20:23] offset:6272
    ds_read_b128 v[20:23], v10 offset:6144
    ds_read_b128 v[132:135], v10 offset:7168
    ds_read_b128 v[164:167], v10 offset:8192
    v_cvt_pk_bf16_f32 v148, v148, v149
    v_cvt_pk_bf16_f32 v149, v150, v151
    v_cvt_pk_bf16_f32 v150, v152, 0
    v_mov_b32 v151, 0
    s_nop 1
    v_mfma_f32_16x16x32_bf16 v[112:115], v[128:131], v[148:151], v[112:115]
    v_mfma_f32_16x16x32_bf16 v[152:155], v[140:143], v[108:111], 0
    v_mfma_f32_16x16x32_bf16 v[152:155], v[160:163], v[148:151], v[152:155]
    v_mfma_f32_16x16x32_bf16 v[128:131], v[36:39], v[108:111], 0
    s_waitcnt lgkmcnt(2)
    buffer_store_dwordx4 v[20:23], v16, s[16:19], s21 offen sc1 nt
    v_mfma_f32_16x16x32_bf16 v[128:131], v[104:107], v[148:151], v[128:131]
    s_waitcnt lgkmcnt(1)
    buffer_store_dwordx4 v[132:135], v17, s[16:19], s21 offen sc1 nt
    v_mfma_f32_16x16x32_bf16 v[20:23], v[88:91], v[108:111], 0
    s_waitcnt lgkmcnt(0)
    buffer_store_dwordx4 v[164:167], v18, s[16:19], s21 offen sc1 nt
    v_mfma_f32_16x16x32_bf16 v[20:23], v[156:159], v[148:151], v[20:23]
    s_add_u32 s24, s21, 436608
    v_and_b32 v11, 48, v0
    v_mfma_f32_16x16x32_bf16 v[104:107], v[116:119], v[108:111], 0
    v_cvt_pk_bf16_f32 v112, v112, v113
    v_cvt_pk_bf16_f32 v113, v114, v115
    v_mfma_f32_16x16x32_bf16 v[104:107], v[124:127], v[148:151], v[104:107]
    v_cvt_pk_bf16_f32 v114, v152, v153
    v_cvt_pk_bf16_f32 v115, v154, v155
    v_mfma_f32_16x16x32_bf16 v[116:119], v[120:123], v[108:111], 0
    v_cvt_pk_bf16_f32 v128, v128, v129
    v_cvt_pk_bf16_f32 v129, v130, v131
    v_mfma_f32_16x16x32_bf16 v[116:119], v[24:27], v[148:151], v[116:119]
    v_cvt_pk_bf16_f32 v130, v20, v21
    v_cvt_pk_bf16_f32 v131, v22, v23
    v_cvt_pk_bf16_f32 v104, v104, v105
    v_cvt_pk_bf16_f32 v105, v106, v107
    s_nop 3
    v_cvt_pk_bf16_f32 v106, v116, v117
    v_cvt_pk_bf16_f32 v107, v118, v119
    s_lshl_b32 exec_lo, 0x10001, s20
    s_mov_b32 exec_hi, exec_lo
    buffer_store_dwordx4 v[112:115], v11, s[16:19], s24 offen offset:0 sc1 nt
    buffer_store_dwordx4 v[128:131], v11, s[16:19], s24 offen offset:64 sc1 nt
    buffer_store_dwordx4 v[104:107], v11, s[16:19], s24 offen offset:128 sc1 nt
    s_mov_b64 exec, -1
    s_endpgm

.section .rodata,"a"
.p2align 6
.amdhsa_kernel standalone__swin_window_attn__vision_kernel
  .amdhsa_next_free_vgpr 168
  .amdhsa_next_free_sgpr 64
  .amdhsa_accum_offset 168
  .amdhsa_group_segment_fixed_size 0
  .amdhsa_kernarg_size 48
  .amdhsa_user_sgpr_count 2
  .amdhsa_user_sgpr_kernarg_segment_ptr 1
  .amdhsa_system_sgpr_workgroup_id_x 1
.end_amdhsa_kernel
```
